```python
import torch

def _softmax(x, axis=-1):
    return torch.softmax(x, dim=axis)
def _gelu(x):
    return torch.nn.functional.gelu(x, approximate="tanh")
def _silu(x):
    return torch.nn.functional.silu(x)
def _sigmoid(x):
    return torch.sigmoid(x)
def _layernorm(x, axis=-1, eps=1e-5):
    m = x.mean(dim=axis, keepdim=True)
    v = x.var(dim=axis, keepdim=True, unbiased=False)
    return (x - m) / torch.sqrt(v + eps)
def _scatter_add(tgt, idx, src, axis=0):
    return tgt.clone().index_add_(axis, idx, src)
def _segment_sum(src, seg, n):
    out = torch.zeros((n,) + src.shape[1:], dtype=src.dtype)
    return out.index_add_(0, seg, src)
def _pad(x, pw):
    flat = tuple(v for pair in reversed(pw) for v in pair)
    return torch.nn.functional.pad(x, flat)

kernel_name = 'standalone__mha_block_cached__near_ridge'

def setup_inputs():

    _w = (lambda a: (lambda t: t.to(torch.bfloat16) if t.is_floating_point() else t)(torch.as_tensor(a)))
    B, Sq, D = 8, 128, 448
    H, Sk, Dh = 16, 512, 256
    return {
        "x": _w((lambda *s: torch.randn(*s, dtype=torch.bfloat16) * 0.8)(B, Sq, D)),
        "k_cache": _w((lambda *s: torch.randn(*s, dtype=torch.bfloat16) * 0.8)(B, H, Sk, Dh)),
        "v_cache": _w((lambda *s: torch.randn(*s, dtype=torch.bfloat16) * 0.05)(B, H, Sk, Dh)),
        "wq": _w((lambda *s: torch.randn(*s, dtype=torch.bfloat16) * 0.8)(D, H * Dh) * (D ** -0.5)),
        "wo": _w((lambda *s: torch.randn(*s, dtype=torch.bfloat16) * 0.05)(H * Dh, D) * ((H * Dh) ** -0.5)),
    }

def reference(x, k_cache, v_cache, wq, wo):
    B, Sq, D = x.shape
    H, Dh = 16, 256
    q = (lambda x, *d: x.permute(*d))((x @ wq).reshape(B, Sq, H, Dh), 0, 2, 1, 3)
    scores = torch.einsum("bhqd,bhkd->bhqk", q, k_cache) * (Dh ** -0.5)
    p = _softmax(scores, axis=-1)
    o = torch.einsum("bhqk,bhkd->bhqd", p, v_cache)
    return (lambda x, *d: x.permute(*d))(o, 0, 2, 1, 3).reshape(B, Sq, H * Dh) @ wo
```

```asm
; @launch kernel=standalone__mha_block_cached__near_ridge_kernel grid=(256,1,1) block=(256,1,1) lds=163840
; @launch kernel=reduce_kernel grid=(224,1,1) block=(256,1,1) lds=0
.amdgcn_target "amdgcn-amd-amdhsa--gfx950"
.text
.globl standalone__mha_block_cached__near_ridge_kernel
.p2align 8
.type standalone__mha_block_cached__near_ridge_kernel,@function
standalone__mha_block_cached__near_ridge_kernel:
    s_cmp_ge_u32 s2, 256
    s_cbranch_scc1 L_main_end
    s_load_dwordx8 s[4:11], s[0:1], 0
    s_load_dwordx8 s[12:19], s[0:1], 32
    v_lshrrev_b32 v4, 6, v0
    v_and_b32 v1, 63, v0
    s_lshr_b32 s54, s2, 5
    v_readfirstlane_b32 s44, v4
    s_and_b32 s55, s2, 7
    s_lshl_b32 s55, s55, 1
    s_lshr_b32 s56, s2, 3
    s_and_b32 s52, s56, 1
    s_add_u32 s55, s55, s52
    s_lshr_b32 s56, s2, 4
    s_and_b32 s56, s56, 1
    s_mov_b32 s53, 0x3db8aa3b
    s_mov_b32 s94, s53
    s_mov_b32 s95, s53
    s_mov_b32 s58, 0xffff0000
    v_and_b32 v2, 31, v1
    v_lshrrev_b32 v3, 5, v1
    s_mul_i32 s45, s44, 24576
    s_waitcnt lgkmcnt(0)
    s_mov_b32 s20, s4
    s_and_b32 s21, s5, 0xffff
    s_mov_b32 s22, 917504
    s_mov_b32 s23, 0x00020000
    s_mov_b32 s24, s6
    s_and_b32 s25, s7, 0xffff
    s_mov_b32 s26, 33554432
    s_mov_b32 s27, 0x00020000
    s_mov_b32 s28, s8
    s_and_b32 s29, s9, 0xffff
    s_mov_b32 s30, 33554432
    s_mov_b32 s31, 0x00020000
    s_mov_b32 s32, s10
    s_and_b32 s33, s11, 0xffff
    s_mov_b32 s34, 3670016
    s_mov_b32 s35, 0x00020000
    s_mov_b32 s36, s12
    s_and_b32 s37, s13, 0xffff
    s_mov_b32 s38, 3670016
    s_mov_b32 s39, 0x00020000
    s_mov_b32 s40, s18
    s_and_b32 s41, s19, 0xffff
    s_mov_b32 s42, 15728640
    s_mov_b32 s43, 0x00020000
    s_lshl_b32 s52, s54, 1
    s_add_u32 s52, s52, s56
    s_mul_i32 s46, s52, 57344
    s_lshl_b32 s47, s55, 9
    s_lshl_b32 s52, s44, 7
    s_add_u32 s47, s47, s52
    s_lshl_b32 s52, s54, 4
    s_add_u32 s52, s52, s55
    s_lshl_b32 s52, s52, 18
    s_lshl_b32 s57, s44, 16
    s_add_u32 s48, s52, s57
    s_lshl_b32 s57, s44, 7
    s_add_u32 s49, s52, s57
    s_add_u32 s57, s44, 0
    s_and_b32 s57, s57, 3
    s_lshl_b32 s57, s57, 7
    s_add_u32 s96, s48, s57
    s_add_u32 s57, s44, 1
    s_and_b32 s57, s57, 3
    s_lshl_b32 s57, s57, 7
    s_add_u32 s97, s48, s57
    s_add_u32 s57, s44, 2
    s_and_b32 s57, s57, 3
    s_lshl_b32 s57, s57, 7
    s_add_u32 s98, s48, s57
    s_add_u32 s57, s44, 3
    s_and_b32 s57, s57, 3
    s_lshl_b32 s57, s57, 7
    s_add_u32 s99, s48, s57
    s_mul_i32 s50, s55, 229376
    s_mul_i32 s52, s44, 224
    s_add_u32 s50, s50, s52
    s_lshl_b32 s52, s2, 2
    s_add_u32 s52, s52, s44
    s_mul_i32 s51, s52, 15360
    v_lshrrev_b32 v4, 3, v1
    v_and_b32 v5, 7, v1
    v_lshrrev_b32 v6, 1, v4
    v_xor_b32 v7, v5, v6
    v_lshlrev_b32 v32, 4, v7
    v_xor_b32 v33, 64, v32
    v_mul_u32_u24 v34, 896, v4
    v_add_u32 v19, v34, v32
    v_add_u32 v20, v34, v33
    v_lshlrev_b32 v34, 9, v4
    v_add_u32 v22, v34, v32
    v_add_u32 v23, v34, v33
    v_and_b32 v7, 1, v6
    v_lshlrev_b32 v7, 2, v7
    v_xor_b32 v7, v5, v7
    v_lshlrev_b32 v7, 4, v7
    v_add_u32 v24, v34, v7
    v_lshlrev_b32 v34, 13, v4
    v_add_u32 v21, v34, v7
    v_add_u32 v4, 0, v1
    v_mul_u32_u24 v5, 4682, v4
    v_lshrrev_b32 v5, 16, v5
    v_mul_u32_u24 v6, 14, v5
    v_sub_u32 v6, v4, v6
    v_mul_u32_u24 v5, 896, v5
    v_lshlrev_b32 v6, 4, v6
    v_add_u32 v25, v5, v6
    v_add_u32 v4, 64, v1
    v_mul_u32_u24 v5, 4682, v4
    v_lshrrev_b32 v5, 16, v5
    v_mul_u32_u24 v6, 14, v5
    v_sub_u32 v6, v4, v6
    v_mul_u32_u24 v5, 896, v5
    v_lshlrev_b32 v6, 4, v6
    v_add_u32 v26, v5, v6
    v_add_u32 v4, 128, v1
    v_mul_u32_u24 v5, 4682, v4
    v_lshrrev_b32 v5, 16, v5
    v_mul_u32_u24 v6, 14, v5
    v_sub_u32 v6, v4, v6
    v_mul_u32_u24 v5, 896, v5
    v_lshlrev_b32 v6, 4, v6
    v_add_u32 v27, v5, v6
    v_add_u32 v4, 192, v1
    v_mul_u32_u24 v5, 4682, v4
    v_lshrrev_b32 v5, 16, v5
    v_mul_u32_u24 v6, 14, v5
    v_sub_u32 v6, v4, v6
    v_mul_u32_u24 v5, 896, v5
    v_lshlrev_b32 v6, 4, v6
    v_add_u32 v28, v5, v6
    v_add_u32 v4, 256, v1
    v_mul_u32_u24 v5, 4682, v4
    v_lshrrev_b32 v5, 16, v5
    v_mul_u32_u24 v6, 14, v5
    v_sub_u32 v6, v4, v6
    v_mul_u32_u24 v5, 896, v5
    v_lshlrev_b32 v6, 4, v6
    v_add_u32 v29, v5, v6
    v_add_u32 v4, 320, v1
    v_mul_u32_u24 v5, 4682, v4
    v_lshrrev_b32 v5, 16, v5
    v_mul_u32_u24 v6, 14, v5
    v_sub_u32 v6, v4, v6
    v_mul_u32_u24 v5, 896, v5
    v_lshlrev_b32 v6, 4, v6
    v_add_u32 v30, v5, v6
    v_add_u32 v4, 384, v1
    v_mul_u32_u24 v5, 4682, v4
    v_lshrrev_b32 v5, 16, v5
    v_mul_u32_u24 v6, 14, v5
    v_sub_u32 v6, v4, v6
    v_mul_u32_u24 v5, 896, v5
    v_lshlrev_b32 v6, 4, v6
    v_add_u32 v31, v5, v6
    s_nop 4
    s_lshl_b32 s60, s54, 1
    s_add_u32 s60, s60, s56
    s_mul_i32 s62, s60, 28
    s_mul_i32 s63, s44, 7
    s_add_u32 s62, s62, s63
    s_lshl_b32 s62, s62, 13
    s_lshl_b32 s63, s55, 9
    s_add_u32 s62, s62, s63
    v_lshlrev_b32 v4, 13, v3
    v_lshl_add_u32 v4, v2, 4, v4
    s_add_u32 s100, s62, 0
    buffer_load_dwordx4 v[192:195], v4, s[32:35], s100 offen
    s_add_u32 s100, s62, 16384
    buffer_load_dwordx4 v[196:199], v4, s[32:35], s100 offen
    s_add_u32 s100, s62, 32768
    buffer_load_dwordx4 v[200:203], v4, s[32:35], s100 offen
    s_add_u32 s100, s62, 40960
    buffer_load_dwordx4 v[204:207], v4, s[32:35], s100 offen
    s_lshl_b32 s63, s55, 8
    s_lshl_b32 s100, s60, 4
    s_add_u32 s63, s63, s100
    s_mul_i32 s63, s63, 896
    s_mul_i32 s100, s44, 3584
    s_add_u32 s101, s63, s100
    s_mul_i32 s57, s44, 14
    s_add_u32 s60, s57, 0
    s_lshr_b32 s61, s60, 3
    s_and_b32 s62, s60, 7
    s_lshl_b32 s63, s60, 10
    s_add_u32 m0, s63, 98304
    s_mul_i32 s63, s62, 7168
    s_lshl_b32 s61, s61, 7
    s_add_u32 s63, s63, s61
    s_add_u32 s63, s63, s46
    buffer_load_dwordx4 v19, s[20:23], s63 offen lds
    s_add_u32 s60, s57, 1
    s_lshr_b32 s61, s60, 3
    s_and_b32 s62, s60, 7
    s_lshl_b32 s63, s60, 10
    s_add_u32 m0, s63, 98304
    s_mul_i32 s63, s62, 7168
    s_lshl_b32 s61, s61, 7
    s_add_u32 s63, s63, s61
    s_add_u32 s63, s63, s46
    buffer_load_dwordx4 v20, s[20:23], s63 offen lds
    s_add_u32 s60, s57, 2
    s_lshr_b32 s61, s60, 3
    s_and_b32 s62, s60, 7
    s_lshl_b32 s63, s60, 10
    s_add_u32 m0, s63, 98304
    s_mul_i32 s63, s62, 7168
    s_lshl_b32 s61, s61, 7
    s_add_u32 s63, s63, s61
    s_add_u32 s63, s63, s46
    buffer_load_dwordx4 v19, s[20:23], s63 offen lds
    s_add_u32 s60, s57, 3
    s_lshr_b32 s61, s60, 3
    s_and_b32 s62, s60, 7
    s_lshl_b32 s63, s60, 10
    s_add_u32 m0, s63, 98304
    s_mul_i32 s63, s62, 7168
    s_lshl_b32 s61, s61, 7
    s_add_u32 s63, s63, s61
    s_add_u32 s63, s63, s46
    buffer_load_dwordx4 v20, s[20:23], s63 offen lds
    s_add_u32 s60, s57, 4
    s_lshr_b32 s61, s60, 3
    s_and_b32 s62, s60, 7
    s_lshl_b32 s63, s60, 10
    s_add_u32 m0, s63, 98304
    s_mul_i32 s63, s62, 7168
    s_lshl_b32 s61, s61, 7
    s_add_u32 s63, s63, s61
    s_add_u32 s63, s63, s46
    buffer_load_dwordx4 v19, s[20:23], s63 offen lds
    s_add_u32 s60, s57, 5
    s_lshr_b32 s61, s60, 3
    s_and_b32 s62, s60, 7
    s_lshl_b32 s63, s60, 10
    s_add_u32 m0, s63, 98304
    s_mul_i32 s63, s62, 7168
    s_lshl_b32 s61, s61, 7
    s_add_u32 s63, s63, s61
    s_add_u32 s63, s63, s46
    buffer_load_dwordx4 v20, s[20:23], s63 offen lds
    s_add_u32 s60, s57, 6
    s_lshr_b32 s61, s60, 3
    s_and_b32 s62, s60, 7
    s_lshl_b32 s63, s60, 10
    s_add_u32 m0, s63, 98304
    s_mul_i32 s63, s62, 7168
    s_lshl_b32 s61, s61, 7
    s_add_u32 s63, s63, s61
    s_add_u32 s63, s63, s46
    buffer_load_dwordx4 v19, s[20:23], s63 offen lds
    s_add_u32 s60, s57, 7
    s_lshr_b32 s61, s60, 3
    s_and_b32 s62, s60, 7
    s_lshl_b32 s63, s60, 10
    s_add_u32 m0, s63, 98304
    s_mul_i32 s63, s62, 7168
    s_lshl_b32 s61, s61, 7
    s_add_u32 s63, s63, s61
    s_add_u32 s63, s63, s46
    buffer_load_dwordx4 v20, s[20:23], s63 offen lds
    s_add_u32 s60, s57, 8
    s_lshr_b32 s61, s60, 3
    s_and_b32 s62, s60, 7
    s_lshl_b32 s63, s60, 10
    s_add_u32 m0, s63, 98304
    s_mul_i32 s63, s62, 7168
    s_lshl_b32 s61, s61, 7
    s_add_u32 s63, s63, s61
    s_add_u32 s63, s63, s46
    buffer_load_dwordx4 v19, s[20:23], s63 offen lds
    s_add_u32 s60, s57, 9
    s_lshr_b32 s61, s60, 3
    s_and_b32 s62, s60, 7
    s_lshl_b32 s63, s60, 10
    s_add_u32 m0, s63, 98304
    s_mul_i32 s63, s62, 7168
    s_lshl_b32 s61, s61, 7
    s_add_u32 s63, s63, s61
    s_add_u32 s63, s63, s46
    buffer_load_dwordx4 v20, s[20:23], s63 offen lds
    s_add_u32 s60, s57, 10
    s_lshr_b32 s61, s60, 3
    s_and_b32 s62, s60, 7
    s_lshl_b32 s63, s60, 10
    s_add_u32 m0, s63, 98304
    s_mul_i32 s63, s62, 7168
    s_lshl_b32 s61, s61, 7
    s_add_u32 s63, s63, s61
    s_add_u32 s63, s63, s46
    buffer_load_dwordx4 v19, s[20:23], s63 offen lds
    s_add_u32 s60, s57, 11
    s_lshr_b32 s61, s60, 3
    s_and_b32 s62, s60, 7
    s_lshl_b32 s63, s60, 10
    s_add_u32 m0, s63, 98304
    s_mul_i32 s63, s62, 7168
    s_lshl_b32 s61, s61, 7
    s_add_u32 s63, s63, s61
    s_add_u32 s63, s63, s46
    buffer_load_dwordx4 v20, s[20:23], s63 offen lds
    s_add_u32 s60, s57, 12
    s_lshr_b32 s61, s60, 3
    s_and_b32 s62, s60, 7
    s_lshl_b32 s63, s60, 10
    s_add_u32 m0, s63, 98304
    s_mul_i32 s63, s62, 7168
    s_lshl_b32 s61, s61, 7
    s_add_u32 s63, s63, s61
    s_add_u32 s63, s63, s46
    buffer_load_dwordx4 v19, s[20:23], s63 offen lds
    s_add_u32 s60, s57, 13
    s_lshr_b32 s61, s60, 3
    s_and_b32 s62, s60, 7
    s_lshl_b32 s63, s60, 10
    s_add_u32 m0, s63, 98304
    s_mul_i32 s63, s62, 7168
    s_lshl_b32 s61, s61, 7
    s_add_u32 s63, s63, s61
    s_add_u32 s63, s63, s46
    buffer_load_dwordx4 v20, s[20:23], s63 offen lds
    s_add_u32 m0, s45, 0
    s_add_u32 s52, s47, 0
    buffer_load_dwordx4 v21, s[32:35], s52 offen lds
    s_add_u32 m0, s45, 1024
    s_add_u32 s52, s47, 65536
    buffer_load_dwordx4 v21, s[32:35], s52 offen lds
    s_add_u32 m0, s45, 2048
    s_add_u32 s52, s47, 131072
    buffer_load_dwordx4 v21, s[32:35], s52 offen lds
    s_add_u32 m0, s45, 3072
    s_add_u32 s52, s47, 196608
    buffer_load_dwordx4 v21, s[32:35], s52 offen lds
    s_add_u32 m0, s45, 4096
    s_add_u32 s52, s47, 262144
    buffer_load_dwordx4 v21, s[32:35], s52 offen lds
    s_add_u32 m0, s45, 5120
    s_add_u32 s52, s47, 327680
    buffer_load_dwordx4 v21, s[32:35], s52 offen lds
    s_add_u32 m0, s45, 6144
    s_add_u32 s52, s47, 393216
    buffer_load_dwordx4 v21, s[32:35], s52 offen lds
    s_add_u32 m0, s45, 7168
    s_add_u32 s52, s47, 458752
    buffer_load_dwordx4 v21, s[32:35], s52 offen lds
    s_add_u32 m0, s45, 8192
    s_add_u32 s52, s47, 524288
    buffer_load_dwordx4 v21, s[32:35], s52 offen lds
    s_add_u32 m0, s45, 9216
    s_add_u32 s52, s47, 589824
    buffer_load_dwordx4 v21, s[32:35], s52 offen lds
    s_add_u32 m0, s45, 10240
    s_add_u32 s52, s47, 655360
    buffer_load_dwordx4 v21, s[32:35], s52 offen lds
    s_add_u32 m0, s45, 11264
    s_add_u32 s52, s47, 720896
    buffer_load_dwordx4 v21, s[32:35], s52 offen lds
    s_add_u32 m0, s45, 12288
    s_add_u32 s52, s47, 786432
    buffer_load_dwordx4 v21, s[32:35], s52 offen lds
    s_add_u32 m0, s45, 13312
    s_add_u32 s52, s47, 851968
    buffer_load_dwordx4 v21, s[32:35], s52 offen lds
    s_add_u32 m0, s45, 14336
    s_add_u32 s52, s47, 917504
    buffer_load_dwordx4 v21, s[32:35], s52 offen lds
    s_add_u32 m0, s45, 15360
    s_add_u32 s52, s47, 983040
    buffer_load_dwordx4 v21, s[32:35], s52 offen lds
    s_add_u32 m0, s45, 16384
    s_add_u32 s52, s47, 1048576
    buffer_load_dwordx4 v21, s[32:35], s52 offen lds
    s_add_u32 m0, s45, 17408
    s_add_u32 s52, s47, 1114112
    buffer_load_dwordx4 v21, s[32:35], s52 offen lds
    s_add_u32 m0, s45, 18432
    s_add_u32 s52, s47, 1179648
    buffer_load_dwordx4 v21, s[32:35], s52 offen lds
    s_add_u32 m0, s45, 19456
    s_add_u32 s52, s47, 1245184
    buffer_load_dwordx4 v21, s[32:35], s52 offen lds
    s_add_u32 m0, s45, 20480
    s_add_u32 s52, s47, 1310720
    buffer_load_dwordx4 v21, s[32:35], s52 offen lds
    s_add_u32 m0, s45, 21504
    s_add_u32 s52, s47, 1376256
    buffer_load_dwordx4 v21, s[32:35], s52 offen lds
    s_add_u32 m0, s45, 22528
    s_add_u32 s52, s47, 1441792
    buffer_load_dwordx4 v21, s[32:35], s52 offen lds
    s_add_u32 m0, s45, 23552
    s_add_u32 s52, s47, 1507328
    buffer_load_dwordx4 v21, s[32:35], s52 offen lds
    v_lshrrev_b32 v4, 1, v2
    v_and_b32 v4, 7, v4
    v_lshlrev_b32 v5, 7, v2
    v_add_u32 v6, 0, v3
    v_xor_b32 v6, v6, v4
    v_lshl_add_u32 v6, v6, 4, v5
    v_add_u32 v8, 98304, v6
    v_add_u32 v12, s45, v6
    v_add_u32 v6, 2, v3
    v_xor_b32 v6, v6, v4
    v_lshl_add_u32 v6, v6, 4, v5
    v_add_u32 v9, 98304, v6
    v_add_u32 v13, s45, v6
    v_add_u32 v6, 4, v3
    v_xor_b32 v6, v6, v4
    v_lshl_add_u32 v6, v6, 4, v5
    v_add_u32 v10, 98304, v6
    v_add_u32 v14, s45, v6
    v_add_u32 v6, 6, v3
    v_xor_b32 v6, v6, v4
    v_lshl_add_u32 v6, v6, 4, v5
    v_add_u32 v11, 98304, v6
    v_add_u32 v15, s45, v6
    v_lshrrev_b32 v4, 4, v1
    v_and_b32 v4, 1, v4
    v_and_b32 v5, 15, v1
    v_lshrrev_b32 v6, 2, v5
    v_and_b32 v7, 3, v5
    v_lshl_add_u32 v32, v3, 3, v6
    v_lshlrev_b32 v32, 7, v32
    v_lshrrev_b32 v33, 1, v7
    v_lshl_add_u32 v33, v4, 1, v33
    v_lshrrev_b32 v34, 1, v6
    v_lshlrev_b32 v34, 2, v34
    v_xor_b32 v33, v33, v34
    v_lshl_add_u32 v32, v33, 4, v32
    v_and_b32 v33, 1, v7
    v_lshl_add_u32 v32, v33, 3, v32
    v_add_u32 v16, s45, v32
    v_xor_b32 v17, 64, v16
    v_lshrrev_b32 v32, 4, v1
    v_lshl_add_u32 v32, v32, 2, v6
    v_mul_u32_u24 v32, 224, v32
    v_lshl_add_u32 v32, v7, 3, v32
    v_add_u32 v18, s45, v32
    s_waitcnt vmcnt(24)
    s_barrier
    s_waitcnt vmcnt(20)
    ds_read_b64_tr_b16 v[64:65], v16 offset:0
    ds_read_b64_tr_b16 v[66:67], v16 offset:512
    ds_read_b64_tr_b16 v[68:69], v17 offset:0
    ds_read_b64_tr_b16 v[70:71], v17 offset:512
    ds_read_b128 v[80:83], v8 offset:0
    ds_read_b128 v[84:87], v8 offset:4096
    ds_read_b64_tr_b16 v[72:73], v16 offset:2048
    ds_read_b64_tr_b16 v[74:75], v16 offset:2560
    ds_read_b64_tr_b16 v[76:77], v17 offset:2048
    ds_read_b64_tr_b16 v[78:79], v17 offset:2560
    ds_read_b128 v[88:91], v9 offset:0
    ds_read_b128 v[92:95], v9 offset:4096
    s_waitcnt lgkmcnt(0)
    v_mfma_f32_32x32x16_bf16 v[128:143], v[64:67], v[80:83], 0
    v_mfma_f32_32x32x16_bf16 v[144:159], v[64:67], v[84:87], 0
    s_add_u32 m0, s45, 0
    s_add_u32 s52, s47, 1572864
    buffer_load_dwordx4 v21, s[32:35], s52 offen lds
    v_mfma_f32_32x32x16_bf16 v[160:175], v[68:71], v[80:83], 0
    v_mfma_f32_32x32x16_bf16 v[176:191], v[68:71], v[84:87], 0
    s_add_u32 m0, s45, 1024
    s_add_u32 s52, s47, 1638400
    buffer_load_dwordx4 v21, s[32:35], s52 offen lds
    s_waitcnt vmcnt(18)
    ds_read_b64_tr_b16 v[96:97], v16 offset:4096
    ds_read_b64_tr_b16 v[98:99], v16 offset:4608
    ds_read_b64_tr_b16 v[100:101], v17 offset:4096
    ds_read_b64_tr_b16 v[102:103], v17 offset:4608
    ds_read_b128 v[112:115], v10 offset:0
    ds_read_b128 v[116:119], v10 offset:4096
    ds_read_b64_tr_b16 v[104:105], v16 offset:6144
    ds_read_b64_tr_b16 v[106:107], v16 offset:6656
    ds_read_b64_tr_b16 v[108:109], v17 offset:6144
    ds_read_b64_tr_b16 v[110:111], v17 offset:6656
    ds_read_b128 v[120:123], v11 offset:0
    ds_read_b128 v[124:127], v11 offset:4096
    v_mfma_f32_32x32x16_bf16 v[128:143], v[72:75], v[88:91], v[128:143]
    v_mfma_f32_32x32x16_bf16 v[144:159], v[72:75], v[92:95], v[144:159]
    s_add_u32 m0, s45, 2048
    s_add_u32 s52, s47, 1703936
    buffer_load_dwordx4 v21, s[32:35], s52 offen lds
    v_mfma_f32_32x32x16_bf16 v[160:175], v[76:79], v[88:91], v[160:175]
    v_mfma_f32_32x32x16_bf16 v[176:191], v[76:79], v[92:95], v[176:191]
    s_add_u32 m0, s45, 3072
    s_add_u32 s52, s47, 1769472
    buffer_load_dwordx4 v21, s[32:35], s52 offen lds
    s_waitcnt lgkmcnt(0)
    v_mfma_f32_32x32x16_bf16 v[128:143], v[96:99], v[112:115], v[128:143]
    v_mfma_f32_32x32x16_bf16 v[144:159], v[96:99], v[116:119], v[144:159]
    s_add_u32 m0, s45, 4096
    s_add_u32 s52, s47, 1835008
    buffer_load_dwordx4 v21, s[32:35], s52 offen lds
    v_mfma_f32_32x32x16_bf16 v[160:175], v[100:103], v[112:115], v[160:175]
    v_mfma_f32_32x32x16_bf16 v[176:191], v[100:103], v[116:119], v[176:191]
    s_add_u32 m0, s45, 5120
    s_add_u32 s52, s47, 1900544
    buffer_load_dwordx4 v21, s[32:35], s52 offen lds
    s_waitcnt vmcnt(18)
    ds_read_b64_tr_b16 v[64:65], v16 offset:8192
    ds_read_b64_tr_b16 v[66:67], v16 offset:8704
    ds_read_b64_tr_b16 v[68:69], v17 offset:8192
    ds_read_b64_tr_b16 v[70:71], v17 offset:8704
    ds_read_b128 v[80:83], v8 offset:8192
    ds_read_b128 v[84:87], v8 offset:12288
    ds_read_b64_tr_b16 v[72:73], v16 offset:10240
    ds_read_b64_tr_b16 v[74:75], v16 offset:10752
    ds_read_b64_tr_b16 v[76:77], v17 offset:10240
    ds_read_b64_tr_b16 v[78:79], v17 offset:10752
    ds_read_b128 v[88:91], v9 offset:8192
    ds_read_b128 v[92:95], v9 offset:12288
    v_mfma_f32_32x32x16_bf16 v[128:143], v[104:107], v[120:123], v[128:143]
    v_mfma_f32_32x32x16_bf16 v[144:159], v[104:107], v[124:127], v[144:159]
    s_add_u32 m0, s45, 6144
    s_add_u32 s52, s47, 1966080
    buffer_load_dwordx4 v21, s[32:35], s52 offen lds
    v_mfma_f32_32x32x16_bf16 v[160:175], v[108:111], v[120:123], v[160:175]
    v_mfma_f32_32x32x16_bf16 v[176:191], v[108:111], v[124:127], v[176:191]
    s_add_u32 m0, s45, 7168
    s_add_u32 s52, s47, 2031616
    buffer_load_dwordx4 v21, s[32:35], s52 offen lds
    s_waitcnt lgkmcnt(0)
    v_mfma_f32_32x32x16_bf16 v[128:143], v[64:67], v[80:83], v[128:143]
    v_mfma_f32_32x32x16_bf16 v[144:159], v[64:67], v[84:87], v[144:159]
    s_add_u32 m0, s45, 8192
    s_add_u32 s52, s47, 2097152
    buffer_load_dwordx4 v21, s[32:35], s52 offen lds
    v_mfma_f32_32x32x16_bf16 v[160:175], v[68:71], v[80:83], v[160:175]
    v_mfma_f32_32x32x16_bf16 v[176:191], v[68:71], v[84:87], v[176:191]
    s_add_u32 m0, s45, 9216
    s_add_u32 s52, s47, 2162688
    buffer_load_dwordx4 v21, s[32:35], s52 offen lds
    s_waitcnt vmcnt(18)
    ds_read_b64_tr_b16 v[96:97], v16 offset:12288
    ds_read_b64_tr_b16 v[98:99], v16 offset:12800
    ds_read_b64_tr_b16 v[100:101], v17 offset:12288
    ds_read_b64_tr_b16 v[102:103], v17 offset:12800
    ds_read_b128 v[112:115], v10 offset:8192
    ds_read_b128 v[116:119], v10 offset:12288
    ds_read_b64_tr_b16 v[104:105], v16 offset:14336
    ds_read_b64_tr_b16 v[106:107], v16 offset:14848
    ds_read_b64_tr_b16 v[108:109], v17 offset:14336
    ds_read_b64_tr_b16 v[110:111], v17 offset:14848
    ds_read_b128 v[120:123], v11 offset:8192
    ds_read_b128 v[124:127], v11 offset:12288
    v_mfma_f32_32x32x16_bf16 v[128:143], v[72:75], v[88:91], v[128:143]
    v_mfma_f32_32x32x16_bf16 v[144:159], v[72:75], v[92:95], v[144:159]
    s_add_u32 m0, s45, 10240
    s_add_u32 s52, s47, 2228224
    buffer_load_dwordx4 v21, s[32:35], s52 offen lds
    v_mfma_f32_32x32x16_bf16 v[160:175], v[76:79], v[88:91], v[160:175]
    v_mfma_f32_32x32x16_bf16 v[176:191], v[76:79], v[92:95], v[176:191]
    s_add_u32 m0, s45, 11264
    s_add_u32 s52, s47, 2293760
    buffer_load_dwordx4 v21, s[32:35], s52 offen lds
    s_waitcnt lgkmcnt(0)
    v_mfma_f32_32x32x16_bf16 v[128:143], v[96:99], v[112:115], v[128:143]
    v_mfma_f32_32x32x16_bf16 v[144:159], v[96:99], v[116:119], v[144:159]
    s_add_u32 m0, s45, 12288
    s_add_u32 s52, s47, 2359296
    buffer_load_dwordx4 v21, s[32:35], s52 offen lds
    v_mfma_f32_32x32x16_bf16 v[160:175], v[100:103], v[112:115], v[160:175]
    v_mfma_f32_32x32x16_bf16 v[176:191], v[100:103], v[116:119], v[176:191]
    s_add_u32 m0, s45, 13312
    s_add_u32 s52, s47, 2424832
    buffer_load_dwordx4 v21, s[32:35], s52 offen lds
    s_waitcnt vmcnt(18)
    ds_read_b64_tr_b16 v[64:65], v16 offset:16384
    ds_read_b64_tr_b16 v[66:67], v16 offset:16896
    ds_read_b64_tr_b16 v[68:69], v17 offset:16384
    ds_read_b64_tr_b16 v[70:71], v17 offset:16896
    ds_read_b128 v[80:83], v8 offset:16384
    ds_read_b128 v[84:87], v8 offset:20480
    ds_read_b64_tr_b16 v[72:73], v16 offset:18432
    ds_read_b64_tr_b16 v[74:75], v16 offset:18944
    ds_read_b64_tr_b16 v[76:77], v17 offset:18432
    ds_read_b64_tr_b16 v[78:79], v17 offset:18944
    ds_read_b128 v[88:91], v9 offset:16384
    ds_read_b128 v[92:95], v9 offset:20480
    v_mfma_f32_32x32x16_bf16 v[128:143], v[104:107], v[120:123], v[128:143]
    v_mfma_f32_32x32x16_bf16 v[144:159], v[104:107], v[124:127], v[144:159]
    s_add_u32 m0, s45, 14336
    s_add_u32 s52, s47, 2490368
    buffer_load_dwordx4 v21, s[32:35], s52 offen lds
    v_mfma_f32_32x32x16_bf16 v[160:175], v[108:111], v[120:123], v[160:175]
    v_mfma_f32_32x32x16_bf16 v[176:191], v[108:111], v[124:127], v[176:191]
    s_add_u32 m0, s45, 15360
    s_add_u32 s52, s47, 2555904
    buffer_load_dwordx4 v21, s[32:35], s52 offen lds
    s_waitcnt lgkmcnt(0)
    v_mfma_f32_32x32x16_bf16 v[128:143], v[64:67], v[80:83], v[128:143]
    v_mfma_f32_32x32x16_bf16 v[144:159], v[64:67], v[84:87], v[144:159]
    s_add_u32 m0, s45, 16384
    s_add_u32 s52, s47, 2621440
    buffer_load_dwordx4 v21, s[32:35], s52 offen lds
    v_mfma_f32_32x32x16_bf16 v[160:175], v[68:71], v[80:83], v[160:175]
    v_mfma_f32_32x32x16_bf16 v[176:191], v[68:71], v[84:87], v[176:191]
    s_add_u32 m0, s45, 17408
    s_add_u32 s52, s47, 2686976
    buffer_load_dwordx4 v21, s[32:35], s52 offen lds
    s_waitcnt vmcnt(18)
    ds_read_b64_tr_b16 v[96:97], v16 offset:20480
    ds_read_b64_tr_b16 v[98:99], v16 offset:20992
    ds_read_b64_tr_b16 v[100:101], v17 offset:20480
    ds_read_b64_tr_b16 v[102:103], v17 offset:20992
    ds_read_b128 v[112:115], v10 offset:16384
    ds_read_b128 v[116:119], v10 offset:20480
    ds_read_b64_tr_b16 v[104:105], v16 offset:22528
    ds_read_b64_tr_b16 v[106:107], v16 offset:23040
    ds_read_b64_tr_b16 v[108:109], v17 offset:22528
    ds_read_b64_tr_b16 v[110:111], v17 offset:23040
    ds_read_b128 v[120:123], v11 offset:16384
    ds_read_b128 v[124:127], v11 offset:20480
    v_mfma_f32_32x32x16_bf16 v[128:143], v[72:75], v[88:91], v[128:143]
    v_mfma_f32_32x32x16_bf16 v[144:159], v[72:75], v[92:95], v[144:159]
    s_add_u32 m0, s45, 18432
    s_add_u32 s52, s47, 2752512
    buffer_load_dwordx4 v21, s[32:35], s52 offen lds
    v_mfma_f32_32x32x16_bf16 v[160:175], v[76:79], v[88:91], v[160:175]
    v_mfma_f32_32x32x16_bf16 v[176:191], v[76:79], v[92:95], v[176:191]
    s_add_u32 m0, s45, 19456
    s_add_u32 s52, s47, 2818048
    buffer_load_dwordx4 v21, s[32:35], s52 offen lds
    s_waitcnt lgkmcnt(0)
    v_mfma_f32_32x32x16_bf16 v[128:143], v[96:99], v[112:115], v[128:143]
    v_mfma_f32_32x32x16_bf16 v[144:159], v[96:99], v[116:119], v[144:159]
    s_add_u32 m0, s45, 20480
    s_add_u32 s52, s47, 2883584
    buffer_load_dwordx4 v21, s[32:35], s52 offen lds
    v_mfma_f32_32x32x16_bf16 v[160:175], v[100:103], v[112:115], v[160:175]
    v_mfma_f32_32x32x16_bf16 v[176:191], v[100:103], v[116:119], v[176:191]
    s_add_u32 m0, s45, 21504
    s_add_u32 s52, s47, 2949120
    buffer_load_dwordx4 v21, s[32:35], s52 offen lds
    s_waitcnt vmcnt(18)
    ds_read_b64_tr_b16 v[64:65], v16 offset:0
    ds_read_b64_tr_b16 v[66:67], v16 offset:512
    ds_read_b64_tr_b16 v[68:69], v17 offset:0
    ds_read_b64_tr_b16 v[70:71], v17 offset:512
    ds_read_b128 v[80:83], v8 offset:24576
    ds_read_b128 v[84:87], v8 offset:28672
    ds_read_b64_tr_b16 v[72:73], v16 offset:2048
    ds_read_b64_tr_b16 v[74:75], v16 offset:2560
    ds_read_b64_tr_b16 v[76:77], v17 offset:2048
    ds_read_b64_tr_b16 v[78:79], v17 offset:2560
    ds_read_b128 v[88:91], v9 offset:24576
    ds_read_b128 v[92:95], v9 offset:28672
    v_mfma_f32_32x32x16_bf16 v[128:143], v[104:107], v[120:123], v[128:143]
    v_mfma_f32_32x32x16_bf16 v[144:159], v[104:107], v[124:127], v[144:159]
    s_add_u32 m0, s45, 22528
    s_add_u32 s52, s47, 3014656
    buffer_load_dwordx4 v21, s[32:35], s52 offen lds
    v_mfma_f32_32x32x16_bf16 v[160:175], v[108:111], v[120:123], v[160:175]
    v_mfma_f32_32x32x16_bf16 v[176:191], v[108:111], v[124:127], v[176:191]
    s_add_u32 m0, s45, 23552
    s_add_u32 s52, s47, 3080192
    buffer_load_dwordx4 v21, s[32:35], s52 offen lds
    s_waitcnt lgkmcnt(0)
    v_mfma_f32_32x32x16_bf16 v[128:143], v[64:67], v[80:83], v[128:143]
    v_mfma_f32_32x32x16_bf16 v[144:159], v[64:67], v[84:87], v[144:159]
    s_add_u32 m0, s45, 0
    s_add_u32 s52, s47, 3145728
    buffer_load_dwordx4 v21, s[32:35], s52 offen lds
    v_mfma_f32_32x32x16_bf16 v[160:175], v[68:71], v[80:83], v[160:175]
    v_mfma_f32_32x32x16_bf16 v[176:191], v[68:71], v[84:87], v[176:191]
    s_add_u32 m0, s45, 1024
    s_add_u32 s52, s47, 3211264
    buffer_load_dwordx4 v21, s[32:35], s52 offen lds
    s_waitcnt vmcnt(18)
    ds_read_b64_tr_b16 v[96:97], v16 offset:4096
    ds_read_b64_tr_b16 v[98:99], v16 offset:4608
    ds_read_b64_tr_b16 v[100:101], v17 offset:4096
    ds_read_b64_tr_b16 v[102:103], v17 offset:4608
    ds_read_b128 v[112:115], v10 offset:24576
    ds_read_b128 v[116:119], v10 offset:28672
    ds_read_b64_tr_b16 v[104:105], v16 offset:6144
    ds_read_b64_tr_b16 v[106:107], v16 offset:6656
    ds_read_b64_tr_b16 v[108:109], v17 offset:6144
    ds_read_b64_tr_b16 v[110:111], v17 offset:6656
    ds_read_b128 v[120:123], v11 offset:24576
    ds_read_b128 v[124:127], v11 offset:28672
    v_mfma_f32_32x32x16_bf16 v[128:143], v[72:75], v[88:91], v[128:143]
    v_mfma_f32_32x32x16_bf16 v[144:159], v[72:75], v[92:95], v[144:159]
    s_add_u32 m0, s45, 2048
    s_add_u32 s52, s47, 3276800
    buffer_load_dwordx4 v21, s[32:35], s52 offen lds
    v_mfma_f32_32x32x16_bf16 v[160:175], v[76:79], v[88:91], v[160:175]
    v_mfma_f32_32x32x16_bf16 v[176:191], v[76:79], v[92:95], v[176:191]
    s_add_u32 m0, s45, 3072
    s_add_u32 s52, s47, 3342336
    buffer_load_dwordx4 v21, s[32:35], s52 offen lds
    s_waitcnt lgkmcnt(0)
    v_mfma_f32_32x32x16_bf16 v[128:143], v[96:99], v[112:115], v[128:143]
    v_mfma_f32_32x32x16_bf16 v[144:159], v[96:99], v[116:119], v[144:159]
    s_add_u32 m0, s45, 4096
    s_add_u32 s52, s47, 3407872
    buffer_load_dwordx4 v21, s[32:35], s52 offen lds
    v_mfma_f32_32x32x16_bf16 v[160:175], v[100:103], v[112:115], v[160:175]
    v_mfma_f32_32x32x16_bf16 v[176:191], v[100:103], v[116:119], v[176:191]
    s_add_u32 m0, s45, 5120
    s_add_u32 s52, s47, 3473408
    buffer_load_dwordx4 v21, s[32:35], s52 offen lds
    s_waitcnt vmcnt(18)
    ds_read_b64_tr_b16 v[64:65], v16 offset:8192
    ds_read_b64_tr_b16 v[66:67], v16 offset:8704
    ds_read_b64_tr_b16 v[68:69], v17 offset:8192
    ds_read_b64_tr_b16 v[70:71], v17 offset:8704
    ds_read_b128 v[80:83], v8 offset:32768
    ds_read_b128 v[84:87], v8 offset:36864
    ds_read_b64_tr_b16 v[72:73], v16 offset:10240
    ds_read_b64_tr_b16 v[74:75], v16 offset:10752
    ds_read_b64_tr_b16 v[76:77], v17 offset:10240
    ds_read_b64_tr_b16 v[78:79], v17 offset:10752
    ds_read_b128 v[88:91], v9 offset:32768
    ds_read_b128 v[92:95], v9 offset:36864
    v_mfma_f32_32x32x16_bf16 v[128:143], v[104:107], v[120:123], v[128:143]
    v_mfma_f32_32x32x16_bf16 v[144:159], v[104:107], v[124:127], v[144:159]
    s_add_u32 m0, s45, 6144
    s_add_u32 s52, s47, 3538944
    buffer_load_dwordx4 v21, s[32:35], s52 offen lds
    v_mfma_f32_32x32x16_bf16 v[160:175], v[108:111], v[120:123], v[160:175]
    v_mfma_f32_32x32x16_bf16 v[176:191], v[108:111], v[124:127], v[176:191]
    s_add_u32 m0, s45, 7168
    s_add_u32 s52, s47, 3604480
    buffer_load_dwordx4 v21, s[32:35], s52 offen lds
    s_waitcnt lgkmcnt(0)
    v_mfma_f32_32x32x16_bf16 v[128:143], v[64:67], v[80:83], v[128:143]
    v_mfma_f32_32x32x16_bf16 v[144:159], v[64:67], v[84:87], v[144:159]
    s_add_u32 m0, s45, 8192
    s_add_u32 s52, s96, 0
    buffer_load_dwordx4 v22, s[24:27], s52 offen nt lds
    v_mfma_f32_32x32x16_bf16 v[160:175], v[68:71], v[80:83], v[160:175]
    v_mfma_f32_32x32x16_bf16 v[176:191], v[68:71], v[84:87], v[176:191]
    s_add_u32 m0, s45, 9216
    s_add_u32 s52, s96, 4096
    buffer_load_dwordx4 v23, s[24:27], s52 offen nt lds
    s_waitcnt vmcnt(18)
    ds_read_b64_tr_b16 v[96:97], v16 offset:12288
    ds_read_b64_tr_b16 v[98:99], v16 offset:12800
    ds_read_b64_tr_b16 v[100:101], v17 offset:12288
    ds_read_b64_tr_b16 v[102:103], v17 offset:12800
    ds_read_b128 v[112:115], v10 offset:32768
    ds_read_b128 v[116:119], v10 offset:36864
    ds_read_b64_tr_b16 v[104:105], v16 offset:14336
    ds_read_b64_tr_b16 v[106:107], v16 offset:14848
    ds_read_b64_tr_b16 v[108:109], v17 offset:14336
    ds_read_b64_tr_b16 v[110:111], v17 offset:14848
    ds_read_b128 v[120:123], v11 offset:32768
    ds_read_b128 v[124:127], v11 offset:36864
    v_mfma_f32_32x32x16_bf16 v[128:143], v[72:75], v[88:91], v[128:143]
    v_mfma_f32_32x32x16_bf16 v[144:159], v[72:75], v[92:95], v[144:159]
    s_add_u32 m0, s45, 10240
    s_add_u32 s52, s96, 8192
    buffer_load_dwordx4 v22, s[24:27], s52 offen nt lds
    v_mfma_f32_32x32x16_bf16 v[160:175], v[76:79], v[88:91], v[160:175]
    v_mfma_f32_32x32x16_bf16 v[176:191], v[76:79], v[92:95], v[176:191]
    s_add_u32 m0, s45, 11264
    s_add_u32 s52, s96, 12288
    buffer_load_dwordx4 v23, s[24:27], s52 offen nt lds
    s_waitcnt lgkmcnt(0)
    v_mfma_f32_32x32x16_bf16 v[128:143], v[96:99], v[112:115], v[128:143]
    v_mfma_f32_32x32x16_bf16 v[144:159], v[96:99], v[116:119], v[144:159]
    s_add_u32 m0, s45, 12288
    s_add_u32 s52, s97, 0
    buffer_load_dwordx4 v22, s[24:27], s52 offen nt lds
    v_mfma_f32_32x32x16_bf16 v[160:175], v[100:103], v[112:115], v[160:175]
    v_mfma_f32_32x32x16_bf16 v[176:191], v[100:103], v[116:119], v[176:191]
    s_add_u32 m0, s45, 13312
    s_add_u32 s52, s97, 4096
    buffer_load_dwordx4 v23, s[24:27], s52 offen nt lds
    s_waitcnt vmcnt(18)
    ds_read_b64_tr_b16 v[64:65], v16 offset:16384
    ds_read_b64_tr_b16 v[66:67], v16 offset:16896
    ds_read_b64_tr_b16 v[68:69], v17 offset:16384
    ds_read_b64_tr_b16 v[70:71], v17 offset:16896
    ds_read_b128 v[80:83], v8 offset:40960
    ds_read_b128 v[84:87], v8 offset:45056
    ds_read_b64_tr_b16 v[72:73], v16 offset:18432
    ds_read_b64_tr_b16 v[74:75], v16 offset:18944
    ds_read_b64_tr_b16 v[76:77], v17 offset:18432
    ds_read_b64_tr_b16 v[78:79], v17 offset:18944
    ds_read_b128 v[88:91], v9 offset:40960
    ds_read_b128 v[92:95], v9 offset:45056
    v_mfma_f32_32x32x16_bf16 v[128:143], v[104:107], v[120:123], v[128:143]
    v_mfma_f32_32x32x16_bf16 v[144:159], v[104:107], v[124:127], v[144:159]
    s_add_u32 m0, s45, 14336
    s_add_u32 s52, s97, 8192
    buffer_load_dwordx4 v22, s[24:27], s52 offen nt lds
    v_mfma_f32_32x32x16_bf16 v[160:175], v[108:111], v[120:123], v[160:175]
    v_mfma_f32_32x32x16_bf16 v[176:191], v[108:111], v[124:127], v[176:191]
    s_add_u32 m0, s45, 15360
    s_add_u32 s52, s97, 12288
    buffer_load_dwordx4 v23, s[24:27], s52 offen nt lds
    s_waitcnt lgkmcnt(0)
    v_mfma_f32_32x32x16_bf16 v[128:143], v[64:67], v[80:83], v[128:143]
    v_mfma_f32_32x32x16_bf16 v[144:159], v[64:67], v[84:87], v[144:159]
    s_add_u32 m0, s45, 16384
    s_add_u32 s52, s98, 0
    buffer_load_dwordx4 v22, s[24:27], s52 offen nt lds
    v_mfma_f32_32x32x16_bf16 v[160:175], v[68:71], v[80:83], v[160:175]
    v_mfma_f32_32x32x16_bf16 v[176:191], v[68:71], v[84:87], v[176:191]
    s_add_u32 m0, s45, 17408
    s_add_u32 s52, s98, 4096
    buffer_load_dwordx4 v23, s[24:27], s52 offen nt lds
    s_waitcnt vmcnt(18)
    ds_read_b64_tr_b16 v[96:97], v16 offset:20480
    ds_read_b64_tr_b16 v[98:99], v16 offset:20992
    ds_read_b64_tr_b16 v[100:101], v17 offset:20480
    ds_read_b64_tr_b16 v[102:103], v17 offset:20992
    ds_read_b128 v[112:115], v10 offset:40960
    ds_read_b128 v[116:119], v10 offset:45056
    ds_read_b64_tr_b16 v[104:105], v16 offset:22528
    ds_read_b64_tr_b16 v[106:107], v16 offset:23040
    ds_read_b64_tr_b16 v[108:109], v17 offset:22528
    ds_read_b64_tr_b16 v[110:111], v17 offset:23040
    ds_read_b128 v[120:123], v11 offset:40960
    ds_read_b128 v[124:127], v11 offset:45056
    v_mfma_f32_32x32x16_bf16 v[128:143], v[72:75], v[88:91], v[128:143]
    v_mfma_f32_32x32x16_bf16 v[144:159], v[72:75], v[92:95], v[144:159]
    s_add_u32 m0, s45, 18432
    s_add_u32 s52, s98, 8192
    buffer_load_dwordx4 v22, s[24:27], s52 offen nt lds
    v_mfma_f32_32x32x16_bf16 v[160:175], v[76:79], v[88:91], v[160:175]
    v_mfma_f32_32x32x16_bf16 v[176:191], v[76:79], v[92:95], v[176:191]
    s_add_u32 m0, s45, 19456
    s_add_u32 s52, s98, 12288
    buffer_load_dwordx4 v23, s[24:27], s52 offen nt lds
    s_waitcnt lgkmcnt(0)
    v_mfma_f32_32x32x16_bf16 v[128:143], v[96:99], v[112:115], v[128:143]
    v_mfma_f32_32x32x16_bf16 v[144:159], v[96:99], v[116:119], v[144:159]
    s_add_u32 m0, s45, 20480
    s_add_u32 s52, s99, 0
    buffer_load_dwordx4 v22, s[24:27], s52 offen nt lds
    v_mfma_f32_32x32x16_bf16 v[160:175], v[100:103], v[112:115], v[160:175]
    v_mfma_f32_32x32x16_bf16 v[176:191], v[100:103], v[116:119], v[176:191]
    s_add_u32 m0, s45, 21504
    s_add_u32 s52, s99, 4096
    buffer_load_dwordx4 v23, s[24:27], s52 offen nt lds
    s_waitcnt vmcnt(18)
    ds_read_b64_tr_b16 v[64:65], v16 offset:0
    ds_read_b64_tr_b16 v[66:67], v16 offset:512
    ds_read_b64_tr_b16 v[68:69], v17 offset:0
    ds_read_b64_tr_b16 v[70:71], v17 offset:512
    ds_read_b128 v[80:83], v8 offset:49152
    ds_read_b128 v[84:87], v8 offset:53248
    ds_read_b64_tr_b16 v[72:73], v16 offset:2048
    ds_read_b64_tr_b16 v[74:75], v16 offset:2560
    ds_read_b64_tr_b16 v[76:77], v17 offset:2048
    ds_read_b64_tr_b16 v[78:79], v17 offset:2560
    ds_read_b128 v[88:91], v9 offset:49152
    ds_read_b128 v[92:95], v9 offset:53248
    v_mfma_f32_32x32x16_bf16 v[128:143], v[104:107], v[120:123], v[128:143]
    v_mfma_f32_32x32x16_bf16 v[144:159], v[104:107], v[124:127], v[144:159]
    s_add_u32 m0, s45, 22528
    s_add_u32 s52, s99, 8192
    buffer_load_dwordx4 v22, s[24:27], s52 offen nt lds
    v_mfma_f32_32x32x16_bf16 v[160:175], v[108:111], v[120:123], v[160:175]
    v_mfma_f32_32x32x16_bf16 v[176:191], v[108:111], v[124:127], v[176:191]
    s_add_u32 m0, s45, 23552
    s_add_u32 s52, s99, 12288
    buffer_load_dwordx4 v23, s[24:27], s52 offen nt lds
    s_waitcnt lgkmcnt(0)
    v_mfma_f32_32x32x16_bf16 v[128:143], v[64:67], v[80:83], v[128:143]
    v_mfma_f32_32x32x16_bf16 v[144:159], v[64:67], v[84:87], v[144:159]
    s_add_u32 m0, s45, 0
    s_add_u32 s52, s96, 16384
    buffer_load_dwordx4 v22, s[24:27], s52 offen nt lds
    v_mfma_f32_32x32x16_bf16 v[160:175], v[68:71], v[80:83], v[160:175]
    v_mfma_f32_32x32x16_bf16 v[176:191], v[68:71], v[84:87], v[176:191]
    s_add_u32 m0, s45, 1024
    s_add_u32 s52, s96, 20480
    buffer_load_dwordx4 v23, s[24:27], s52 offen nt lds
    s_waitcnt vmcnt(18)
    ds_read_b64_tr_b16 v[96:97], v16 offset:4096
    ds_read_b64_tr_b16 v[98:99], v16 offset:4608
    ds_read_b64_tr_b16 v[100:101], v17 offset:4096
    ds_read_b64_tr_b16 v[102:103], v17 offset:4608
    ds_read_b128 v[112:115], v10 offset:49152
    ds_read_b128 v[116:119], v10 offset:53248
    ds_read_b64_tr_b16 v[104:105], v16 offset:6144
    ds_read_b64_tr_b16 v[106:107], v16 offset:6656
    ds_read_b64_tr_b16 v[108:109], v17 offset:6144
    ds_read_b64_tr_b16 v[110:111], v17 offset:6656
    ds_read_b128 v[120:123], v11 offset:49152
    ds_read_b128 v[124:127], v11 offset:53248
    v_mfma_f32_32x32x16_bf16 v[128:143], v[72:75], v[88:91], v[128:143]
    v_mfma_f32_32x32x16_bf16 v[144:159], v[72:75], v[92:95], v[144:159]
    s_add_u32 m0, s45, 2048
    s_add_u32 s52, s96, 24576
    buffer_load_dwordx4 v22, s[24:27], s52 offen nt lds
    v_mfma_f32_32x32x16_bf16 v[160:175], v[76:79], v[88:91], v[160:175]
    v_mfma_f32_32x32x16_bf16 v[176:191], v[76:79], v[92:95], v[176:191]
    s_add_u32 m0, s45, 3072
    s_add_u32 s52, s96, 28672
    buffer_load_dwordx4 v23, s[24:27], s52 offen nt lds
    s_waitcnt lgkmcnt(0)
    v_mfma_f32_32x32x16_bf16 v[128:143], v[96:99], v[112:115], v[128:143]
    v_mfma_f32_32x32x16_bf16 v[144:159], v[96:99], v[116:119], v[144:159]
    s_add_u32 m0, s45, 4096
    s_add_u32 s52, s97, 16384
    buffer_load_dwordx4 v22, s[24:27], s52 offen nt lds
    v_mfma_f32_32x32x16_bf16 v[160:175], v[100:103], v[112:115], v[160:175]
    v_mfma_f32_32x32x16_bf16 v[176:191], v[100:103], v[116:119], v[176:191]
    s_add_u32 m0, s45, 5120
    s_add_u32 s52, s97, 20480
    buffer_load_dwordx4 v23, s[24:27], s52 offen nt lds
    v_mfma_f32_32x32x16_bf16 v[128:143], v[104:107], v[120:123], v[128:143]
    v_mfma_f32_32x32x16_bf16 v[144:159], v[104:107], v[124:127], v[144:159]
    s_add_u32 m0, s45, 6144
    s_add_u32 s52, s97, 24576
    buffer_load_dwordx4 v22, s[24:27], s52 offen nt lds
    v_mfma_f32_32x32x16_bf16 v[160:175], v[108:111], v[120:123], v[160:175]
    v_mfma_f32_32x32x16_bf16 v[176:191], v[108:111], v[124:127], v[176:191]
    s_add_u32 m0, s45, 7168
    s_add_u32 s52, s97, 28672
    buffer_load_dwordx4 v23, s[24:27], s52 offen nt lds
    v_lshlrev_b32 v5, 4, v1
    s_add_u32 s100, s101, 0
    buffer_load_dwordx4 v[192:195], v5, s[36:39], s100 offen
    s_add_u32 s100, s101, 1024
    buffer_load_dwordx4 v[196:199], v5, s[36:39], s100 offen
    s_add_u32 s100, s101, 2048
    buffer_load_dwordx4 v[200:203], v5, s[36:39], s100 offen
    s_add_u32 s100, s101, 2560
    buffer_load_dwordx4 v[204:207], v5, s[36:39], s100 offen
    s_barrier
    s_nop 15
    s_lshr_b32 s52, s44, 1
    s_lshl_b32 s52, s52, 8
    s_add_u32 s52, s52, 98304
    s_and_b32 s57, s44, 1
    s_lshl_b32 s57, s57, 3
    v_and_b32 v4, 15, v2
    v_xor_b32 v4, s57, v4
    v_lshlrev_b32 v4, 4, v4
    v_lshl_add_u32 v4, v2, 9, v4
    v_lshl_add_u32 v4, v3, 3, v4
    v_add_u32 v32, s52, v4
    v_cvt_pk_bf16_f32 v40, v128, v129
    v_cvt_pk_bf16_f32 v41, v130, v131
    v_xor_b32 v33, 0, v32
    ds_write_b64 v33, v[40:41] offset:0
    v_cvt_pk_bf16_f32 v40, v132, v133
    v_cvt_pk_bf16_f32 v41, v134, v135
    v_xor_b32 v33, 16, v32
    ds_write_b64 v33, v[40:41] offset:0
    v_cvt_pk_bf16_f32 v40, v136, v137
    v_cvt_pk_bf16_f32 v41, v138, v139
    v_xor_b32 v33, 32, v32
    ds_write_b64 v33, v[40:41] offset:0
    v_cvt_pk_bf16_f32 v40, v140, v141
    v_cvt_pk_bf16_f32 v41, v142, v143
    v_xor_b32 v33, 48, v32
    ds_write_b64 v33, v[40:41] offset:0
    v_cvt_pk_bf16_f32 v40, v144, v145
    v_cvt_pk_bf16_f32 v41, v146, v147
    v_xor_b32 v33, 0, v32
    ds_write_b64 v33, v[40:41] offset:16384
    v_cvt_pk_bf16_f32 v40, v148, v149
    v_cvt_pk_bf16_f32 v41, v150, v151
    v_xor_b32 v33, 16, v32
    ds_write_b64 v33, v[40:41] offset:16384
    v_cvt_pk_bf16_f32 v40, v152, v153
    v_cvt_pk_bf16_f32 v41, v154, v155
    v_xor_b32 v33, 32, v32
    ds_write_b64 v33, v[40:41] offset:16384
    v_cvt_pk_bf16_f32 v40, v156, v157
    v_cvt_pk_bf16_f32 v41, v158, v159
    v_xor_b32 v33, 48, v32
    ds_write_b64 v33, v[40:41] offset:16384
    v_cvt_pk_bf16_f32 v40, v160, v161
    v_cvt_pk_bf16_f32 v41, v162, v163
    v_xor_b32 v33, 64, v32
    ds_write_b64 v33, v[40:41] offset:0
    v_cvt_pk_bf16_f32 v40, v164, v165
    v_cvt_pk_bf16_f32 v41, v166, v167
    v_xor_b32 v33, 80, v32
    ds_write_b64 v33, v[40:41] offset:0
    v_cvt_pk_bf16_f32 v40, v168, v169
    v_cvt_pk_bf16_f32 v41, v170, v171
    v_xor_b32 v33, 96, v32
    ds_write_b64 v33, v[40:41] offset:0
    v_cvt_pk_bf16_f32 v40, v172, v173
    v_cvt_pk_bf16_f32 v41, v174, v175
    v_xor_b32 v33, 112, v32
    ds_write_b64 v33, v[40:41] offset:0
    v_cvt_pk_bf16_f32 v40, v176, v177
    v_cvt_pk_bf16_f32 v41, v178, v179
    v_xor_b32 v33, 64, v32
    ds_write_b64 v33, v[40:41] offset:16384
    v_cvt_pk_bf16_f32 v40, v180, v181
    v_cvt_pk_bf16_f32 v41, v182, v183
    v_xor_b32 v33, 80, v32
    ds_write_b64 v33, v[40:41] offset:16384
    v_cvt_pk_bf16_f32 v40, v184, v185
    v_cvt_pk_bf16_f32 v41, v186, v187
    v_xor_b32 v33, 96, v32
    ds_write_b64 v33, v[40:41] offset:16384
    v_cvt_pk_bf16_f32 v40, v188, v189
    v_cvt_pk_bf16_f32 v41, v190, v191
    v_xor_b32 v33, 112, v32
    ds_write_b64 v33, v[40:41] offset:16384
    s_waitcnt lgkmcnt(0)
    s_barrier
    v_and_b32 v4, 15, v2
    v_xor_b32 v4, v3, v4
    v_lshlrev_b32 v4, 4, v4
    v_lshl_add_u32 v4, v2, 9, v4
    v_add_u32 v32, 98304, v4
    s_add_u32 s57, s44, 0
    s_and_b32 s57, s57, 3
    s_lshl_b32 s57, s57, 7
    v_xor_b32 v33, s57, v32
    v_xor_b32 v34, 0, v33
    ds_read_b128 a[0:3], v34 offset:0
    ds_read_b128 a[4:7], v34 offset:16384
    v_xor_b32 v34, 32, v33
    ds_read_b128 a[8:11], v34 offset:0
    ds_read_b128 a[12:15], v34 offset:16384
    v_xor_b32 v34, 64, v33
    ds_read_b128 a[16:19], v34 offset:0
    ds_read_b128 a[20:23], v34 offset:16384
    v_xor_b32 v34, 96, v33
    ds_read_b128 a[24:27], v34 offset:0
    ds_read_b128 a[28:31], v34 offset:16384
    s_waitcnt lgkmcnt(0)
    s_add_u32 s57, s44, 1
    s_and_b32 s57, s57, 3
    s_lshl_b32 s57, s57, 7
    v_xor_b32 v33, s57, v32
    v_xor_b32 v34, 0, v33
    ds_read_b128 a[32:35], v34 offset:0
    ds_read_b128 a[36:39], v34 offset:16384
    v_xor_b32 v34, 32, v33
    ds_read_b128 a[40:43], v34 offset:0
    ds_read_b128 a[44:47], v34 offset:16384
    v_xor_b32 v34, 64, v33
    ds_read_b128 a[48:51], v34 offset:0
    ds_read_b128 a[52:55], v34 offset:16384
    v_xor_b32 v34, 96, v33
    ds_read_b128 a[56:59], v34 offset:0
    ds_read_b128 a[60:63], v34 offset:16384
    s_waitcnt lgkmcnt(0)
    s_add_u32 s57, s44, 2
    s_and_b32 s57, s57, 3
    s_lshl_b32 s57, s57, 7
    v_xor_b32 v33, s57, v32
    v_xor_b32 v34, 0, v33
    ds_read_b128 a[64:67], v34 offset:0
    ds_read_b128 a[68:71], v34 offset:16384
    v_xor_b32 v34, 32, v33
    ds_read_b128 a[72:75], v34 offset:0
    ds_read_b128 a[76:79], v34 offset:16384
    v_xor_b32 v34, 64, v33
    ds_read_b128 a[80:83], v34 offset:0
    ds_read_b128 a[84:87], v34 offset:16384
    v_xor_b32 v34, 96, v33
    ds_read_b128 a[88:91], v34 offset:0
    ds_read_b128 a[92:95], v34 offset:16384
    s_waitcnt lgkmcnt(0)
    s_add_u32 s57, s44, 3
    s_and_b32 s57, s57, 3
    s_lshl_b32 s57, s57, 7
    v_xor_b32 v33, s57, v32
    v_xor_b32 v34, 0, v33
    ds_read_b128 a[96:99], v34 offset:0
    ds_read_b128 a[100:103], v34 offset:16384
    v_xor_b32 v34, 32, v33
    ds_read_b128 a[104:107], v34 offset:0
    ds_read_b128 a[108:111], v34 offset:16384
    v_xor_b32 v34, 64, v33
    ds_read_b128 a[112:115], v34 offset:0
    ds_read_b128 a[116:119], v34 offset:16384
    v_xor_b32 v34, 96, v33
    ds_read_b128 a[120:123], v34 offset:0
    ds_read_b128 a[124:127], v34 offset:16384
    s_waitcnt lgkmcnt(0)
    s_waitcnt vmcnt(24)
    ds_read_b128 v[64:67], v12 offset:8192
    ds_read_b128 v[68:71], v13 offset:8192
    ds_read_b128 v[72:75], v14 offset:8192
    ds_read_b128 v[76:79], v15 offset:8192
    s_waitcnt lgkmcnt(0)
    v_mfma_f32_32x32x16_bf16 v[128:143], v[64:67], a[0:3], 0
    v_mfma_f32_32x32x16_bf16 v[144:159], v[64:67], a[4:7], 0
    s_add_u32 m0, s45, 8192
    s_add_u32 s52, s98, 16384
    buffer_load_dwordx4 v22, s[24:27], s52 offen nt lds
    v_mfma_f32_32x32x16_bf16 v[128:143], v[68:71], a[8:11], v[128:143]
    v_mfma_f32_32x32x16_bf16 v[144:159], v[68:71], a[12:15], v[144:159]
    s_add_u32 m0, s45, 9216
    s_add_u32 s52, s98, 20480
    buffer_load_dwordx4 v23, s[24:27], s52 offen nt lds
    s_waitcnt vmcnt(22)
    ds_read_b128 v[96:99], v12 offset:12288
    ds_read_b128 v[100:103], v13 offset:12288
    ds_read_b128 v[104:107], v14 offset:12288
    ds_read_b128 v[108:111], v15 offset:12288
    v_mfma_f32_32x32x16_bf16 v[128:143], v[72:75], a[16:19], v[128:143]
    v_mfma_f32_32x32x16_bf16 v[144:159], v[72:75], a[20:23], v[144:159]
    s_add_u32 m0, s45, 10240
    s_add_u32 s52, s98, 24576
    buffer_load_dwordx4 v22, s[24:27], s52 offen nt lds
    v_mfma_f32_32x32x16_bf16 v[128:143], v[76:79], a[24:27], v[128:143]
    v_mfma_f32_32x32x16_bf16 v[144:159], v[76:79], a[28:31], v[144:159]
    s_add_u32 m0, s45, 11264
    s_add_u32 s52, s98, 28672
    buffer_load_dwordx4 v23, s[24:27], s52 offen nt lds
    s_waitcnt lgkmcnt(0)
    v_mfma_f32_32x32x16_bf16 v[128:143], v[96:99], a[32:35], v[128:143]
    v_mfma_f32_32x32x16_bf16 v[144:159], v[96:99], a[36:39], v[144:159]
    s_add_u32 m0, s45, 12288
    s_add_u32 s52, s99, 16384
    buffer_load_dwordx4 v22, s[24:27], s52 offen nt lds
    v_mfma_f32_32x32x16_bf16 v[128:143], v[100:103], a[40:43], v[128:143]
    v_mfma_f32_32x32x16_bf16 v[144:159], v[100:103], a[44:47], v[144:159]
    s_add_u32 m0, s45, 13312
    s_add_u32 s52, s99, 20480
    buffer_load_dwordx4 v23, s[24:27], s52 offen nt lds
    s_waitcnt vmcnt(22)
    ds_read_b128 v[64:67], v12 offset:16384
    ds_read_b128 v[68:71], v13 offset:16384
    ds_read_b128 v[72:75], v14 offset:16384
    ds_read_b128 v[76:79], v15 offset:16384
    v_mfma_f32_32x32x16_bf16 v[128:143], v[104:107], a[48:51], v[128:143]
    v_mfma_f32_32x32x16_bf16 v[144:159], v[104:107], a[52:55], v[144:159]
    s_add_u32 m0, s45, 14336
    s_add_u32 s52, s99, 24576
    buffer_load_dwordx4 v22, s[24:27], s52 offen nt lds
    v_mfma_f32_32x32x16_bf16 v[128:143], v[108:111], a[56:59], v[128:143]
    v_mfma_f32_32x32x16_bf16 v[144:159], v[108:111], a[60:63], v[144:159]
    s_add_u32 m0, s45, 15360
    s_add_u32 s52, s99, 28672
    buffer_load_dwordx4 v23, s[24:27], s52 offen nt lds
    s_waitcnt lgkmcnt(0)
    v_mfma_f32_32x32x16_bf16 v[128:143], v[64:67], a[64:67], v[128:143]
    v_mfma_f32_32x32x16_bf16 v[144:159], v[64:67], a[68:71], v[144:159]
    s_add_u32 m0, s45, 16384
    s_add_u32 s52, s96, 32768
    buffer_load_dwordx4 v22, s[24:27], s52 offen nt lds
    v_mfma_f32_32x32x16_bf16 v[128:143], v[68:71], a[72:75], v[128:143]
    v_mfma_f32_32x32x16_bf16 v[144:159], v[68:71], a[76:79], v[144:159]
    s_add_u32 m0, s45, 17408
    s_add_u32 s52, s96, 36864
    buffer_load_dwordx4 v23, s[24:27], s52 offen nt lds
    s_waitcnt vmcnt(22)
    ds_read_b128 v[96:99], v12 offset:20480
    ds_read_b128 v[100:103], v13 offset:20480
    ds_read_b128 v[104:107], v14 offset:20480
    ds_read_b128 v[108:111], v15 offset:20480
    v_mfma_f32_32x32x16_bf16 v[128:143], v[72:75], a[80:83], v[128:143]
    v_mfma_f32_32x32x16_bf16 v[144:159], v[72:75], a[84:87], v[144:159]
    s_add_u32 m0, s45, 18432
    s_add_u32 s52, s96, 40960
    buffer_load_dwordx4 v22, s[24:27], s52 offen nt lds
    v_mfma_f32_32x32x16_bf16 v[128:143], v[76:79], a[88:91], v[128:143]
    v_mfma_f32_32x32x16_bf16 v[144:159], v[76:79], a[92:95], v[144:159]
    s_add_u32 m0, s45, 19456
    s_add_u32 s52, s96, 45056
    buffer_load_dwordx4 v23, s[24:27], s52 offen nt lds
    s_waitcnt lgkmcnt(0)
    v_mfma_f32_32x32x16_bf16 v[128:143], v[96:99], a[96:99], v[128:143]
    v_mfma_f32_32x32x16_bf16 v[144:159], v[96:99], a[100:103], v[144:159]
    s_add_u32 m0, s45, 20480
    s_add_u32 s52, s97, 32768
    buffer_load_dwordx4 v22, s[24:27], s52 offen nt lds
    v_mfma_f32_32x32x16_bf16 v[128:143], v[100:103], a[104:107], v[128:143]
    v_mfma_f32_32x32x16_bf16 v[144:159], v[100:103], a[108:111], v[144:159]
    s_add_u32 m0, s45, 21504
    s_add_u32 s52, s97, 36864
    buffer_load_dwordx4 v23, s[24:27], s52 offen nt lds
    s_waitcnt vmcnt(22)
    ds_read_b128 v[64:67], v12 offset:0
    ds_read_b128 v[68:71], v13 offset:0
    ds_read_b128 v[72:75], v14 offset:0
    ds_read_b128 v[76:79], v15 offset:0
    v_mfma_f32_32x32x16_bf16 v[128:143], v[104:107], a[112:115], v[128:143]
    v_mfma_f32_32x32x16_bf16 v[144:159], v[104:107], a[116:119], v[144:159]
    s_add_u32 m0, s45, 22528
    s_add_u32 s52, s97, 40960
    buffer_load_dwordx4 v22, s[24:27], s52 offen nt lds
    v_mfma_f32_32x32x16_bf16 v[128:143], v[108:111], a[120:123], v[128:143]
    v_mfma_f32_32x32x16_bf16 v[144:159], v[108:111], a[124:127], v[144:159]
    s_add_u32 m0, s45, 23552
    s_add_u32 s52, s97, 45056
    buffer_load_dwordx4 v23, s[24:27], s52 offen nt lds
    s_waitcnt lgkmcnt(0)
    v_mfma_f32_32x32x16_bf16 v[160:175], v[64:67], a[0:3], 0
    v_mfma_f32_32x32x16_bf16 v[176:191], v[64:67], a[4:7], 0
    s_add_u32 m0, s45, 0
    s_add_u32 s52, s98, 32768
    buffer_load_dwordx4 v22, s[24:27], s52 offen nt lds
    v_mfma_f32_32x32x16_bf16 v[160:175], v[68:71], a[8:11], v[160:175]
    v_mfma_f32_32x32x16_bf16 v[176:191], v[68:71], a[12:15], v[176:191]
    s_add_u32 m0, s45, 1024
    s_add_u32 s52, s98, 36864
    buffer_load_dwordx4 v23, s[24:27], s52 offen nt lds
    s_waitcnt vmcnt(22)
    ds_read_b128 v[96:99], v12 offset:4096
    ds_read_b128 v[100:103], v13 offset:4096
    ds_read_b128 v[104:107], v14 offset:4096
    ds_read_b128 v[108:111], v15 offset:4096
    v_mfma_f32_32x32x16_bf16 v[160:175], v[72:75], a[16:19], v[160:175]
    v_mfma_f32_32x32x16_bf16 v[176:191], v[72:75], a[20:23], v[176:191]
    s_add_u32 m0, s45, 2048
    s_add_u32 s52, s98, 40960
    buffer_load_dwordx4 v22, s[24:27], s52 offen nt lds
    v_mfma_f32_32x32x16_bf16 v[160:175], v[76:79], a[24:27], v[160:175]
    v_mfma_f32_32x32x16_bf16 v[176:191], v[76:79], a[28:31], v[176:191]
    s_add_u32 m0, s45, 3072
    s_add_u32 s52, s98, 45056
    buffer_load_dwordx4 v23, s[24:27], s52 offen nt lds
    s_waitcnt lgkmcnt(0)
    v_mfma_f32_32x32x16_bf16 v[160:175], v[96:99], a[32:35], v[160:175]
    v_cvt_pk_bf16_f32 v129, v128, v129
    v_lshlrev_b32 v128, 16, v129
    v_and_b32 v129, s58, v129
    v_cvt_pk_bf16_f32 v131, v130, v131
    v_mfma_f32_32x32x16_bf16 v[176:191], v[96:99], a[36:39], v[176:191]
    v_lshlrev_b32 v130, 16, v131
    v_and_b32 v131, s58, v131
    v_cvt_pk_bf16_f32 v133, v132, v133
    v_lshlrev_b32 v132, 16, v133
    s_add_u32 m0, s45, 4096
    s_add_u32 s52, s99, 32768
    buffer_load_dwordx4 v22, s[24:27], s52 offen nt lds
    v_mfma_f32_32x32x16_bf16 v[160:175], v[100:103], a[40:43], v[160:175]
    v_and_b32 v133, s58, v133
    v_cvt_pk_bf16_f32 v135, v134, v135
    v_lshlrev_b32 v134, 16, v135
    v_and_b32 v135, s58, v135
    v_mfma_f32_32x32x16_bf16 v[176:191], v[100:103], a[44:47], v[176:191]
    v_cvt_pk_bf16_f32 v137, v136, v137
    v_lshlrev_b32 v136, 16, v137
    v_and_b32 v137, s58, v137
    v_cvt_pk_bf16_f32 v139, v138, v139
    s_add_u32 m0, s45, 5120
    s_add_u32 s52, s99, 36864
    buffer_load_dwordx4 v23, s[24:27], s52 offen nt lds
    s_waitcnt vmcnt(18)
    ds_read_b128 v[64:67], v12 offset:8192
    ds_read_b128 v[68:71], v13 offset:8192
    ds_read_b128 v[72:75], v14 offset:8192
    ds_read_b128 v[76:79], v15 offset:8192
    v_mfma_f32_32x32x16_bf16 v[160:175], v[104:107], a[48:51], v[160:175]
    v_lshlrev_b32 v138, 16, v139
    v_and_b32 v139, s58, v139
    v_cvt_pk_bf16_f32 v141, v140, v141
    v_lshlrev_b32 v140, 16, v141
    v_mfma_f32_32x32x16_bf16 v[176:191], v[104:107], a[52:55], v[176:191]
    v_and_b32 v141, s58, v141
    v_cvt_pk_bf16_f32 v143, v142, v143
    v_lshlrev_b32 v142, 16, v143
    v_and_b32 v143, s58, v143
    s_add_u32 m0, s45, 6144
    s_add_u32 s52, s99, 40960
    buffer_load_dwordx4 v22, s[24:27], s52 offen nt lds
    v_mfma_f32_32x32x16_bf16 v[160:175], v[108:111], a[56:59], v[160:175]
    v_cvt_pk_bf16_f32 v145, v144, v145
    v_lshlrev_b32 v144, 16, v145
    v_and_b32 v145, s58, v145
    v_cvt_pk_bf16_f32 v147, v146, v147
    v_mfma_f32_32x32x16_bf16 v[176:191], v[108:111], a[60:63], v[176:191]
    v_lshlrev_b32 v146, 16, v147
    v_and_b32 v147, s58, v147
    v_cvt_pk_bf16_f32 v149, v148, v149
    v_lshlrev_b32 v148, 16, v149
    s_add_u32 m0, s45, 7168
    s_add_u32 s52, s99, 45056
    buffer_load_dwordx4 v23, s[24:27], s52 offen nt lds
    s_waitcnt lgkmcnt(0)
    v_mfma_f32_32x32x16_bf16 v[160:175], v[64:67], a[64:67], v[160:175]
    v_and_b32 v149, s58, v149
    v_cvt_pk_bf16_f32 v151, v150, v151
    v_lshlrev_b32 v150, 16, v151
    v_and_b32 v151, s58, v151
    v_mfma_f32_32x32x16_bf16 v[176:191], v[64:67], a[68:71], v[176:191]
    v_cvt_pk_bf16_f32 v153, v152, v153
    v_lshlrev_b32 v152, 16, v153
    v_and_b32 v153, s58, v153
    v_cvt_pk_bf16_f32 v155, v154, v155
    s_add_u32 m0, s45, 8192
    s_add_u32 s52, s96, 49152
    buffer_load_dwordx4 v22, s[24:27], s52 offen nt lds
    v_mfma_f32_32x32x16_bf16 v[160:175], v[68:71], a[72:75], v[160:175]
    v_lshlrev_b32 v154, 16, v155
    v_and_b32 v155, s58, v155
    v_cvt_pk_bf16_f32 v157, v156, v157
    v_lshlrev_b32 v156, 16, v157
    v_mfma_f32_32x32x16_bf16 v[176:191], v[68:71], a[76:79], v[176:191]
    v_and_b32 v157, s58, v157
    v_cvt_pk_bf16_f32 v159, v158, v159
    v_lshlrev_b32 v158, 16, v159
    v_and_b32 v159, s58, v159
    s_add_u32 m0, s45, 9216
    s_add_u32 s52, s96, 53248
    buffer_load_dwordx4 v23, s[24:27], s52 offen nt lds
    s_waitcnt vmcnt(18)
    ds_read_b128 v[96:99], v12 offset:12288
    ds_read_b128 v[100:103], v13 offset:12288
    ds_read_b128 v[104:107], v14 offset:12288
    ds_read_b128 v[108:111], v15 offset:12288
    v_mfma_f32_32x32x16_bf16 v[160:175], v[72:75], a[80:83], v[160:175]
    v_max_f32 v80, v128, v129
    v_max_f32 v81, v144, v145
    v_max3_f32 v80, v80, v130, v131
    v_max3_f32 v81, v81, v146, v147
    v_mfma_f32_32x32x16_bf16 v[176:191], v[72:75], a[84:87], v[176:191]
    v_max3_f32 v80, v80, v132, v133
    v_max3_f32 v81, v81, v148, v149
    v_max3_f32 v80, v80, v134, v135
    v_max3_f32 v81, v81, v150, v151
    s_add_u32 m0, s45, 10240
    s_add_u32 s52, s96, 57344
    buffer_load_dwordx4 v22, s[24:27], s52 offen nt lds
    v_mfma_f32_32x32x16_bf16 v[160:175], v[76:79], a[88:91], v[160:175]
    v_max3_f32 v80, v80, v136, v137
    v_max3_f32 v81, v81, v152, v153
    v_max3_f32 v80, v80, v138, v139
    v_max3_f32 v81, v81, v154, v155
    v_mfma_f32_32x32x16_bf16 v[176:191], v[76:79], a[92:95], v[176:191]
    v_max3_f32 v80, v80, v140, v141
    v_max3_f32 v81, v81, v156, v157
    v_max3_f32 v80, v80, v142, v143
    v_max3_f32 v81, v81, v158, v159
    s_add_u32 m0, s45, 11264
    s_add_u32 s52, s96, 61440
    buffer_load_dwordx4 v23, s[24:27], s52 offen nt lds
    s_waitcnt lgkmcnt(0)
    v_mfma_f32_32x32x16_bf16 v[160:175], v[96:99], a[96:99], v[160:175]
    v_mul_f32 v120, s53, v80
    v_mul_f32 v122, s53, v81
    v_pk_fma_f32 v[128:129], v[128:129], s[94:95], v[120:121] op_sel_hi:[1,0,0] neg_lo:[0,0,1] neg_hi:[0,0,1]
    v_pk_fma_f32 v[144:145], v[144:145], s[94:95], v[122:123] op_sel_hi:[1,0,0] neg_lo:[0,0,1] neg_hi:[0,0,1]
    v_mfma_f32_32x32x16_bf16 v[176:191], v[96:99], a[100:103], v[176:191]
    v_exp_f32 v128, v128
    v_exp_f32 v129, v129
    v_exp_f32 v144, v144
    v_exp_f32 v145, v145
    s_add_u32 m0, s45, 12288
    s_add_u32 s52, s97, 49152
    buffer_load_dwordx4 v22, s[24:27], s52 offen nt lds
    v_mfma_f32_32x32x16_bf16 v[160:175], v[100:103], a[104:107], v[160:175]
    v_pk_fma_f32 v[130:131], v[130:131], s[94:95], v[120:121] op_sel_hi:[1,0,0] neg_lo:[0,0,1] neg_hi:[0,0,1]
    v_pk_fma_f32 v[146:147], v[146:147], s[94:95], v[122:123] op_sel_hi:[1,0,0] neg_lo:[0,0,1] neg_hi:[0,0,1]
    v_exp_f32 v130, v130
    v_exp_f32 v131, v131
    v_mfma_f32_32x32x16_bf16 v[176:191], v[100:103], a[108:111], v[176:191]
    v_exp_f32 v146, v146
    v_exp_f32 v147, v147
    v_pk_fma_f32 v[132:133], v[132:133], s[94:95], v[120:121] op_sel_hi:[1,0,0] neg_lo:[0,0,1] neg_hi:[0,0,1]
    v_pk_fma_f32 v[148:149], v[148:149], s[94:95], v[122:123] op_sel_hi:[1,0,0] neg_lo:[0,0,1] neg_hi:[0,0,1]
    s_add_u32 m0, s45, 13312
    s_add_u32 s52, s97, 53248
    buffer_load_dwordx4 v23, s[24:27], s52 offen nt lds
    s_waitcnt vmcnt(18)
    ds_read_b128 v[64:67], v12 offset:16384
    ds_read_b128 v[68:71], v13 offset:16384
    ds_read_b128 v[72:75], v14 offset:16384
    ds_read_b128 v[76:79], v15 offset:16384
    v_mfma_f32_32x32x16_bf16 v[160:175], v[104:107], a[112:115], v[160:175]
    v_exp_f32 v132, v132
    v_exp_f32 v133, v133
    v_exp_f32 v148, v148
    v_exp_f32 v149, v149
    v_mfma_f32_32x32x16_bf16 v[176:191], v[104:107], a[116:119], v[176:191]
    v_pk_fma_f32 v[134:135], v[134:135], s[94:95], v[120:121] op_sel_hi:[1,0,0] neg_lo:[0,0,1] neg_hi:[0,0,1]
    v_pk_fma_f32 v[150:151], v[150:151], s[94:95], v[122:123] op_sel_hi:[1,0,0] neg_lo:[0,0,1] neg_hi:[0,0,1]
    v_exp_f32 v134, v134
    v_exp_f32 v135, v135
    s_add_u32 m0, s45, 14336
    s_add_u32 s52, s97, 57344
    buffer_load_dwordx4 v22, s[24:27], s52 offen nt lds
    v_mfma_f32_32x32x16_bf16 v[160:175], v[108:111], a[120:123], v[160:175]
    v_exp_f32 v150, v150
    v_exp_f32 v151, v151
    v_pk_fma_f32 v[136:137], v[136:137], s[94:95], v[120:121] op_sel_hi:[1,0,0] neg_lo:[0,0,1] neg_hi:[0,0,1]
    v_pk_fma_f32 v[152:153], v[152:153], s[94:95], v[122:123] op_sel_hi:[1,0,0] neg_lo:[0,0,1] neg_hi:[0,0,1]
    v_mfma_f32_32x32x16_bf16 v[176:191], v[108:111], a[124:127], v[176:191]
    v_exp_f32 v136, v136
    v_exp_f32 v137, v137
    v_exp_f32 v152, v152
    v_exp_f32 v153, v153
    s_add_u32 m0, s45, 15360
    s_add_u32 s52, s97, 61440
    buffer_load_dwordx4 v23, s[24:27], s52 offen nt lds
    s_waitcnt lgkmcnt(0)
    v_mfma_f32_32x32x16_bf16 v[192:207], v[64:67], a[0:3], 0
    v_pk_fma_f32 v[138:139], v[138:139], s[94:95], v[120:121] op_sel_hi:[1,0,0] neg_lo:[0,0,1] neg_hi:[0,0,1]
    v_pk_fma_f32 v[154:155], v[154:155], s[94:95], v[122:123] op_sel_hi:[1,0,0] neg_lo:[0,0,1] neg_hi:[0,0,1]
    v_exp_f32 v138, v138
    v_exp_f32 v139, v139
    v_mfma_f32_32x32x16_bf16 v[208:223], v[64:67], a[4:7], 0
    v_exp_f32 v154, v154
    v_exp_f32 v155, v155
    v_pk_fma_f32 v[140:141], v[140:141], s[94:95], v[120:121] op_sel_hi:[1,0,0] neg_lo:[0,0,1] neg_hi:[0,0,1]
    v_pk_fma_f32 v[156:157], v[156:157], s[94:95], v[122:123] op_sel_hi:[1,0,0] neg_lo:[0,0,1] neg_hi:[0,0,1]
    s_add_u32 m0, s45, 16384
    s_add_u32 s52, s98, 49152
    buffer_load_dwordx4 v22, s[24:27], s52 offen nt lds
    v_mfma_f32_32x32x16_bf16 v[192:207], v[68:71], a[8:11], v[192:207]
    v_exp_f32 v140, v140
    v_exp_f32 v141, v141
    v_exp_f32 v156, v156
    v_exp_f32 v157, v157
    v_mfma_f32_32x32x16_bf16 v[208:223], v[68:71], a[12:15], v[208:223]
    v_pk_fma_f32 v[142:143], v[142:143], s[94:95], v[120:121] op_sel_hi:[1,0,0] neg_lo:[0,0,1] neg_hi:[0,0,1]
    v_pk_fma_f32 v[158:159], v[158:159], s[94:95], v[122:123] op_sel_hi:[1,0,0] neg_lo:[0,0,1] neg_hi:[0,0,1]
    v_exp_f32 v142, v142
    v_exp_f32 v143, v143
    s_add_u32 m0, s45, 17408
    s_add_u32 s52, s98, 53248
    buffer_load_dwordx4 v23, s[24:27], s52 offen nt lds
    s_waitcnt vmcnt(18)
    ds_read_b128 v[96:99], v12 offset:20480
    ds_read_b128 v[100:103], v13 offset:20480
    ds_read_b128 v[104:107], v14 offset:20480
    ds_read_b128 v[108:111], v15 offset:20480
    v_mfma_f32_32x32x16_bf16 v[192:207], v[72:75], a[16:19], v[192:207]
    v_exp_f32 v158, v158
    v_exp_f32 v159, v159
    v_pk_add_f32 v[112:113], v[128:129], v[130:131]
    v_pk_add_f32 v[114:115], v[144:145], v[146:147]
    v_mfma_f32_32x32x16_bf16 v[208:223], v[72:75], a[20:23], v[208:223]
    v_pk_add_f32 v[112:113], v[112:113], v[132:133]
    v_pk_add_f32 v[114:115], v[114:115], v[148:149]
    v_pk_add_f32 v[112:113], v[112:113], v[134:135]
    v_pk_add_f32 v[114:115], v[114:115], v[150:151]
    s_add_u32 m0, s45, 18432
    s_add_u32 s52, s98, 57344
    buffer_load_dwordx4 v22, s[24:27], s52 offen nt lds
    v_mfma_f32_32x32x16_bf16 v[192:207], v[76:79], a[24:27], v[192:207]
    v_pk_add_f32 v[112:113], v[112:113], v[136:137]
    v_pk_add_f32 v[114:115], v[114:115], v[152:153]
    v_pk_add_f32 v[112:113], v[112:113], v[138:139]
    v_pk_add_f32 v[114:115], v[114:115], v[154:155]
    v_mfma_f32_32x32x16_bf16 v[208:223], v[76:79], a[28:31], v[208:223]
    v_pk_add_f32 v[112:113], v[112:113], v[140:141]
    v_pk_add_f32 v[114:115], v[114:115], v[156:157]
    v_pk_add_f32 v[112:113], v[112:113], v[142:143]
    v_pk_add_f32 v[114:115], v[114:115], v[158:159]
    s_add_u32 m0, s45, 19456
    s_add_u32 s52, s98, 61440
    buffer_load_dwordx4 v23, s[24:27], s52 offen nt lds
    s_waitcnt lgkmcnt(0)
    v_mfma_f32_32x32x16_bf16 v[192:207], v[96:99], a[32:35], v[192:207]
    v_add_f32 v88, v112, v113
    v_add_f32 v89, v114, v115
    v_cvt_pk_bf16_f32 v161, v160, v161
    v_lshlrev_b32 v160, 16, v161
    v_mfma_f32_32x32x16_bf16 v[208:223], v[96:99], a[36:39], v[208:223]
    v_and_b32 v161, s58, v161
    v_cvt_pk_bf16_f32 v163, v162, v163
    v_lshlrev_b32 v162, 16, v163
    v_and_b32 v163, s58, v163
    s_add_u32 m0, s45, 20480
    s_add_u32 s52, s99, 49152
    buffer_load_dwordx4 v22, s[24:27], s52 offen nt lds
    v_mfma_f32_32x32x16_bf16 v[192:207], v[100:103], a[40:43], v[192:207]
    v_cvt_pk_bf16_f32 v165, v164, v165
    v_lshlrev_b32 v164, 16, v165
    v_and_b32 v165, s58, v165
    v_cvt_pk_bf16_f32 v167, v166, v167
    v_mfma_f32_32x32x16_bf16 v[208:223], v[100:103], a[44:47], v[208:223]
    v_lshlrev_b32 v166, 16, v167
    v_and_b32 v167, s58, v167
    v_cvt_pk_bf16_f32 v169, v168, v169
    v_lshlrev_b32 v168, 16, v169
    s_add_u32 m0, s45, 21504
    s_add_u32 s52, s99, 53248
    buffer_load_dwordx4 v23, s[24:27], s52 offen nt lds
    s_waitcnt vmcnt(18)
    ds_read_b128 v[64:67], v12 offset:0
    ds_read_b128 v[68:71], v13 offset:0
    ds_read_b128 v[72:75], v14 offset:0
    ds_read_b128 v[76:79], v15 offset:0
    v_mfma_f32_32x32x16_bf16 v[192:207], v[104:107], a[48:51], v[192:207]
    v_and_b32 v169, s58, v169
    v_cvt_pk_bf16_f32 v171, v170, v171
    v_lshlrev_b32 v170, 16, v171
    v_and_b32 v171, s58, v171
    v_mfma_f32_32x32x16_bf16 v[208:223], v[104:107], a[52:55], v[208:223]
    v_cvt_pk_bf16_f32 v173, v172, v173
    v_lshlrev_b32 v172, 16, v173
    v_and_b32 v173, s58, v173
    v_cvt_pk_bf16_f32 v175, v174, v175
    s_add_u32 m0, s45, 22528
    s_add_u32 s52, s99, 57344
    buffer_load_dwordx4 v22, s[24:27], s52 offen nt lds
    v_mfma_f32_32x32x16_bf16 v[192:207], v[108:111], a[56:59], v[192:207]
    v_lshlrev_b32 v174, 16, v175
    v_and_b32 v175, s58, v175
    v_cvt_pk_bf16_f32 v177, v176, v177
    v_lshlrev_b32 v176, 16, v177
    v_mfma_f32_32x32x16_bf16 v[208:223], v[108:111], a[60:63], v[208:223]
    v_and_b32 v177, s58, v177
    v_cvt_pk_bf16_f32 v179, v178, v179
    v_lshlrev_b32 v178, 16, v179
    v_and_b32 v179, s58, v179
    s_add_u32 m0, s45, 23552
    s_add_u32 s52, s99, 61440
    buffer_load_dwordx4 v23, s[24:27], s52 offen nt lds
    s_waitcnt lgkmcnt(0)
    v_mfma_f32_32x32x16_bf16 v[192:207], v[64:67], a[64:67], v[192:207]
    v_cvt_pk_bf16_f32 v181, v180, v181
    v_lshlrev_b32 v180, 16, v181
    v_and_b32 v181, s58, v181
    v_cvt_pk_bf16_f32 v183, v182, v183
    v_mfma_f32_32x32x16_bf16 v[208:223], v[64:67], a[68:71], v[208:223]
    v_lshlrev_b32 v182, 16, v183
    v_and_b32 v183, s58, v183
    v_cvt_pk_bf16_f32 v185, v184, v185
    v_lshlrev_b32 v184, 16, v185
    s_add_u32 m0, s45, 0
    s_add_u32 s52, s49, 0
    buffer_load_dwordx4 v24, s[28:31], s52 offen nt lds
    v_mfma_f32_32x32x16_bf16 v[192:207], v[68:71], a[72:75], v[192:207]
    v_and_b32 v185, s58, v185
    v_cvt_pk_bf16_f32 v187, v186, v187
    v_lshlrev_b32 v186, 16, v187
    v_and_b32 v187, s58, v187
    v_mfma_f32_32x32x16_bf16 v[208:223], v[68:71], a[76:79], v[208:223]
    v_cvt_pk_bf16_f32 v189, v188, v189
    v_lshlrev_b32 v188, 16, v189
    v_and_b32 v189, s58, v189
    v_cvt_pk_bf16_f32 v191, v190, v191
    s_add_u32 m0, s45, 1024
    s_add_u32 s52, s49, 4096
    buffer_load_dwordx4 v24, s[28:31], s52 offen nt lds
    s_waitcnt vmcnt(18)
    ds_read_b128 v[96:99], v12 offset:4096
    ds_read_b128 v[100:103], v13 offset:4096
    ds_read_b128 v[104:107], v14 offset:4096
    ds_read_b128 v[108:111], v15 offset:4096
    v_mfma_f32_32x32x16_bf16 v[192:207], v[72:75], a[80:83], v[192:207]
    v_lshlrev_b32 v190, 16, v191
    v_and_b32 v191, s58, v191
    v_max_f32 v82, v160, v161
    v_max_f32 v83, v176, v177
    v_mfma_f32_32x32x16_bf16 v[208:223], v[72:75], a[84:87], v[208:223]
    v_max3_f32 v82, v82, v162, v163
    v_max3_f32 v83, v83, v178, v179
    v_max3_f32 v82, v82, v164, v165
    v_max3_f32 v83, v83, v180, v181
    s_add_u32 m0, s45, 2048
    s_add_u32 s52, s49, 8192
    buffer_load_dwordx4 v24, s[28:31], s52 offen nt lds
    v_mfma_f32_32x32x16_bf16 v[192:207], v[76:79], a[88:91], v[192:207]
    v_max3_f32 v82, v82, v166, v167
    v_max3_f32 v83, v83, v182, v183
    v_max3_f32 v82, v82, v168, v169
    v_max3_f32 v83, v83, v184, v185
    v_mfma_f32_32x32x16_bf16 v[208:223], v[76:79], a[92:95], v[208:223]
    v_max3_f32 v82, v82, v170, v171
    v_max3_f32 v83, v83, v186, v187
    v_max3_f32 v82, v82, v172, v173
    v_max3_f32 v83, v83, v188, v189
    s_add_u32 m0, s45, 3072
    s_add_u32 s52, s49, 12288
    buffer_load_dwordx4 v24, s[28:31], s52 offen nt lds
    s_waitcnt lgkmcnt(0)
    v_mfma_f32_32x32x16_bf16 v[192:207], v[96:99], a[96:99], v[192:207]
    v_max3_f32 v82, v82, v174, v175
    v_max3_f32 v83, v83, v190, v191
    v_mul_f32 v120, s53, v82
    v_mul_f32 v122, s53, v83
    v_mfma_f32_32x32x16_bf16 v[208:223], v[96:99], a[100:103], v[208:223]
    v_pk_fma_f32 v[160:161], v[160:161], s[94:95], v[120:121] op_sel_hi:[1,0,0] neg_lo:[0,0,1] neg_hi:[0,0,1]
    v_pk_fma_f32 v[176:177], v[176:177], s[94:95], v[122:123] op_sel_hi:[1,0,0] neg_lo:[0,0,1] neg_hi:[0,0,1]
    v_exp_f32 v160, v160
    v_exp_f32 v161, v161
    s_add_u32 m0, s45, 4096
    s_add_u32 s52, s49, 16384
    buffer_load_dwordx4 v24, s[28:31], s52 offen nt lds
    v_mfma_f32_32x32x16_bf16 v[192:207], v[100:103], a[104:107], v[192:207]
    v_exp_f32 v176, v176
    v_exp_f32 v177, v177
    v_pk_fma_f32 v[162:163], v[162:163], s[94:95], v[120:121] op_sel_hi:[1,0,0] neg_lo:[0,0,1] neg_hi:[0,0,1]
    v_pk_fma_f32 v[178:179], v[178:179], s[94:95], v[122:123] op_sel_hi:[1,0,0] neg_lo:[0,0,1] neg_hi:[0,0,1]
    v_mfma_f32_32x32x16_bf16 v[208:223], v[100:103], a[108:111], v[208:223]
    v_exp_f32 v162, v162
    v_exp_f32 v163, v163
    v_exp_f32 v178, v178
    v_exp_f32 v179, v179
    s_add_u32 m0, s45, 5120
    s_add_u32 s52, s49, 20480
    buffer_load_dwordx4 v24, s[28:31], s52 offen nt lds
    s_waitcnt vmcnt(18)
    ds_read_b128 v[64:67], v12 offset:8192
    ds_read_b128 v[68:71], v13 offset:8192
    ds_read_b128 v[72:75], v14 offset:8192
    ds_read_b128 v[76:79], v15 offset:8192
    v_mfma_f32_32x32x16_bf16 v[192:207], v[104:107], a[112:115], v[192:207]
    v_pk_fma_f32 v[164:165], v[164:165], s[94:95], v[120:121] op_sel_hi:[1,0,0] neg_lo:[0,0,1] neg_hi:[0,0,1]
    v_pk_fma_f32 v[180:181], v[180:181], s[94:95], v[122:123] op_sel_hi:[1,0,0] neg_lo:[0,0,1] neg_hi:[0,0,1]
    v_exp_f32 v164, v164
    v_exp_f32 v165, v165
    v_mfma_f32_32x32x16_bf16 v[208:223], v[104:107], a[116:119], v[208:223]
    v_exp_f32 v180, v180
    v_exp_f32 v181, v181
    v_pk_fma_f32 v[166:167], v[166:167], s[94:95], v[120:121] op_sel_hi:[1,0,0] neg_lo:[0,0,1] neg_hi:[0,0,1]
    v_pk_fma_f32 v[182:183], v[182:183], s[94:95], v[122:123] op_sel_hi:[1,0,0] neg_lo:[0,0,1] neg_hi:[0,0,1]
    s_add_u32 m0, s45, 6144
    s_add_u32 s52, s49, 24576
    buffer_load_dwordx4 v24, s[28:31], s52 offen nt lds
    v_mfma_f32_32x32x16_bf16 v[192:207], v[108:111], a[120:123], v[192:207]
    v_exp_f32 v166, v166
    v_exp_f32 v167, v167
    v_exp_f32 v182, v182
    v_exp_f32 v183, v183
    v_mfma_f32_32x32x16_bf16 v[208:223], v[108:111], a[124:127], v[208:223]
    v_pk_fma_f32 v[168:169], v[168:169], s[94:95], v[120:121] op_sel_hi:[1,0,0] neg_lo:[0,0,1] neg_hi:[0,0,1]
    v_pk_fma_f32 v[184:185], v[184:185], s[94:95], v[122:123] op_sel_hi:[1,0,0] neg_lo:[0,0,1] neg_hi:[0,0,1]
    v_exp_f32 v168, v168
    v_exp_f32 v169, v169
    s_add_u32 m0, s45, 7168
    s_add_u32 s52, s49, 28672
    buffer_load_dwordx4 v24, s[28:31], s52 offen nt lds
    s_waitcnt lgkmcnt(0)
    v_mfma_f32_32x32x16_bf16 v[224:239], v[64:67], a[0:3], 0
    v_exp_f32 v184, v184
    v_exp_f32 v185, v185
    v_pk_fma_f32 v[170:171], v[170:171], s[94:95], v[120:121] op_sel_hi:[1,0,0] neg_lo:[0,0,1] neg_hi:[0,0,1]
    v_pk_fma_f32 v[186:187], v[186:187], s[94:95], v[122:123] op_sel_hi:[1,0,0] neg_lo:[0,0,1] neg_hi:[0,0,1]
    v_mfma_f32_32x32x16_bf16 v[240:255], v[64:67], a[4:7], 0
    v_exp_f32 v170, v170
    v_exp_f32 v171, v171
    v_exp_f32 v186, v186
    v_exp_f32 v187, v187
    s_add_u32 m0, s45, 8192
    s_add_u32 s52, s49, 32768
    buffer_load_dwordx4 v24, s[28:31], s52 offen nt lds
    v_mfma_f32_32x32x16_bf16 v[224:239], v[68:71], a[8:11], v[224:239]
    v_pk_fma_f32 v[172:173], v[172:173], s[94:95], v[120:121] op_sel_hi:[1,0,0] neg_lo:[0,0,1] neg_hi:[0,0,1]
    v_pk_fma_f32 v[188:189], v[188:189], s[94:95], v[122:123] op_sel_hi:[1,0,0] neg_lo:[0,0,1] neg_hi:[0,0,1]
    v_exp_f32 v172, v172
    v_exp_f32 v173, v173
    v_mfma_f32_32x32x16_bf16 v[240:255], v[68:71], a[12:15], v[240:255]
    v_exp_f32 v188, v188
    v_exp_f32 v189, v189
    v_pk_fma_f32 v[174:175], v[174:175], s[94:95], v[120:121] op_sel_hi:[1,0,0] neg_lo:[0,0,1] neg_hi:[0,0,1]
    v_pk_fma_f32 v[190:191], v[190:191], s[94:95], v[122:123] op_sel_hi:[1,0,0] neg_lo:[0,0,1] neg_hi:[0,0,1]
    s_add_u32 m0, s45, 9216
    s_add_u32 s52, s49, 36864
    buffer_load_dwordx4 v24, s[28:31], s52 offen nt lds
    s_waitcnt vmcnt(18)
    ds_read_b128 v[96:99], v12 offset:12288
    ds_read_b128 v[100:103], v13 offset:12288
    ds_read_b128 v[104:107], v14 offset:12288
    ds_read_b128 v[108:111], v15 offset:12288
    v_mfma_f32_32x32x16_bf16 v[224:239], v[72:75], a[16:19], v[224:239]
    v_exp_f32 v174, v174
    v_exp_f32 v175, v175
    v_exp_f32 v190, v190
    v_exp_f32 v191, v191
    v_mfma_f32_32x32x16_bf16 v[240:255], v[72:75], a[20:23], v[240:255]
    v_pk_add_f32 v[112:113], v[160:161], v[162:163]
    v_pk_add_f32 v[114:115], v[176:177], v[178:179]
    v_pk_add_f32 v[112:113], v[112:113], v[164:165]
    v_pk_add_f32 v[114:115], v[114:115], v[180:181]
    s_add_u32 m0, s45, 10240
    s_add_u32 s52, s49, 40960
    buffer_load_dwordx4 v24, s[28:31], s52 offen nt lds
    v_mfma_f32_32x32x16_bf16 v[224:239], v[76:79], a[24:27], v[224:239]
    v_pk_add_f32 v[112:113], v[112:113], v[166:167]
    v_pk_add_f32 v[114:115], v[114:115], v[182:183]
    v_pk_add_f32 v[112:113], v[112:113], v[168:169]
    v_pk_add_f32 v[114:115], v[114:115], v[184:185]
    v_mfma_f32_32x32x16_bf16 v[240:255], v[76:79], a[28:31], v[240:255]
    v_pk_add_f32 v[112:113], v[112:113], v[170:171]
    v_pk_add_f32 v[114:115], v[114:115], v[186:187]
    v_pk_add_f32 v[112:113], v[112:113], v[172:173]
    v_pk_add_f32 v[114:115], v[114:115], v[188:189]
    s_add_u32 m0, s45, 11264
    s_add_u32 s52, s49, 45056
    buffer_load_dwordx4 v24, s[28:31], s52 offen nt lds
    s_waitcnt lgkmcnt(0)
    v_mfma_f32_32x32x16_bf16 v[224:239], v[96:99], a[32:35], v[224:239]
    v_pk_add_f32 v[112:113], v[112:113], v[174:175]
    v_pk_add_f32 v[114:115], v[114:115], v[190:191]
    v_add_f32 v90, v112, v113
    v_add_f32 v91, v114, v115
    v_mfma_f32_32x32x16_bf16 v[240:255], v[96:99], a[36:39], v[240:255]
    v_cvt_pk_bf16_f32 v193, v192, v193
    v_lshlrev_b32 v192, 16, v193
    v_and_b32 v193, s58, v193
    v_cvt_pk_bf16_f32 v195, v194, v195
    s_add_u32 m0, s45, 12288
    s_add_u32 s52, s49, 49152
    buffer_load_dwordx4 v24, s[28:31], s52 offen nt lds
    v_mfma_f32_32x32x16_bf16 v[224:239], v[100:103], a[40:43], v[224:239]
    v_lshlrev_b32 v194, 16, v195
    v_and_b32 v195, s58, v195
    v_cvt_pk_bf16_f32 v197, v196, v197
    v_lshlrev_b32 v196, 16, v197
    v_mfma_f32_32x32x16_bf16 v[240:255], v[100:103], a[44:47], v[240:255]
    v_and_b32 v197, s58, v197
    v_cvt_pk_bf16_f32 v199, v198, v199
    v_lshlrev_b32 v198, 16, v199
    v_and_b32 v199, s58, v199
    s_add_u32 m0, s45, 13312
    s_add_u32 s52, s49, 53248
    buffer_load_dwordx4 v24, s[28:31], s52 offen nt lds
    s_waitcnt vmcnt(18)
    ds_read_b128 v[64:67], v12 offset:16384
    ds_read_b128 v[68:71], v13 offset:16384
    ds_read_b128 v[72:75], v14 offset:16384
    ds_read_b128 v[76:79], v15 offset:16384
    v_mfma_f32_32x32x16_bf16 v[224:239], v[104:107], a[48:51], v[224:239]
    v_cvt_pk_bf16_f32 v201, v200, v201
    v_lshlrev_b32 v200, 16, v201
    v_and_b32 v201, s58, v201
    v_cvt_pk_bf16_f32 v203, v202, v203
    v_mfma_f32_32x32x16_bf16 v[240:255], v[104:107], a[52:55], v[240:255]
    v_lshlrev_b32 v202, 16, v203
    v_and_b32 v203, s58, v203
    v_cvt_pk_bf16_f32 v205, v204, v205
    v_lshlrev_b32 v204, 16, v205
    s_add_u32 m0, s45, 14336
    s_add_u32 s52, s49, 57344
    buffer_load_dwordx4 v24, s[28:31], s52 offen nt lds
    v_mfma_f32_32x32x16_bf16 v[224:239], v[108:111], a[56:59], v[224:239]
    v_and_b32 v205, s58, v205
    v_cvt_pk_bf16_f32 v207, v206, v207
    v_lshlrev_b32 v206, 16, v207
    v_and_b32 v207, s58, v207
    v_mfma_f32_32x32x16_bf16 v[240:255], v[108:111], a[60:63], v[240:255]
    v_cvt_pk_bf16_f32 v209, v208, v209
    v_lshlrev_b32 v208, 16, v209
    v_and_b32 v209, s58, v209
    v_cvt_pk_bf16_f32 v211, v210, v211
    s_add_u32 m0, s45, 15360
    s_add_u32 s52, s49, 61440
    buffer_load_dwordx4 v24, s[28:31], s52 offen nt lds
    s_waitcnt lgkmcnt(0)
    v_mfma_f32_32x32x16_bf16 v[224:239], v[64:67], a[64:67], v[224:239]
    v_lshlrev_b32 v210, 16, v211
    v_and_b32 v211, s58, v211
    v_cvt_pk_bf16_f32 v213, v212, v213
    v_lshlrev_b32 v212, 16, v213
    v_mfma_f32_32x32x16_bf16 v[240:255], v[64:67], a[68:71], v[240:255]
    v_and_b32 v213, s58, v213
    v_cvt_pk_bf16_f32 v215, v214, v215
    v_lshlrev_b32 v214, 16, v215
    v_and_b32 v215, s58, v215
    s_add_u32 m0, s45, 16384
    s_add_u32 s52, s49, 65536
    buffer_load_dwordx4 v24, s[28:31], s52 offen nt lds
    v_mfma_f32_32x32x16_bf16 v[224:239], v[68:71], a[72:75], v[224:239]
    v_cvt_pk_bf16_f32 v217, v216, v217
    v_lshlrev_b32 v216, 16, v217
    v_and_b32 v217, s58, v217
    v_cvt_pk_bf16_f32 v219, v218, v219
    v_mfma_f32_32x32x16_bf16 v[240:255], v[68:71], a[76:79], v[240:255]
    v_lshlrev_b32 v218, 16, v219
    v_and_b32 v219, s58, v219
    v_cvt_pk_bf16_f32 v221, v220, v221
    v_lshlrev_b32 v220, 16, v221
    s_add_u32 m0, s45, 17408
    s_add_u32 s52, s49, 69632
    buffer_load_dwordx4 v24, s[28:31], s52 offen nt lds
    s_waitcnt vmcnt(18)
    ds_read_b128 v[96:99], v12 offset:20480
    ds_read_b128 v[100:103], v13 offset:20480
    ds_read_b128 v[104:107], v14 offset:20480
    ds_read_b128 v[108:111], v15 offset:20480
    v_mfma_f32_32x32x16_bf16 v[224:239], v[72:75], a[80:83], v[224:239]
    v_and_b32 v221, s58, v221
    v_cvt_pk_bf16_f32 v223, v222, v223
    v_lshlrev_b32 v222, 16, v223
    v_and_b32 v223, s58, v223
    v_mfma_f32_32x32x16_bf16 v[240:255], v[72:75], a[84:87], v[240:255]
    v_max_f32 v84, v192, v193
    v_max_f32 v85, v208, v209
    v_max3_f32 v84, v84, v194, v195
    v_max3_f32 v85, v85, v210, v211
    s_add_u32 m0, s45, 18432
    s_add_u32 s52, s49, 73728
    buffer_load_dwordx4 v24, s[28:31], s52 offen nt lds
    v_mfma_f32_32x32x16_bf16 v[224:239], v[76:79], a[88:91], v[224:239]
    v_max3_f32 v84, v84, v196, v197
    v_max3_f32 v85, v85, v212, v213
    v_max3_f32 v84, v84, v198, v199
    v_max3_f32 v85, v85, v214, v215
    v_mfma_f32_32x32x16_bf16 v[240:255], v[76:79], a[92:95], v[240:255]
    v_max3_f32 v84, v84, v200, v201
    v_max3_f32 v85, v85, v216, v217
    v_max3_f32 v84, v84, v202, v203
    v_max3_f32 v85, v85, v218, v219
    s_add_u32 m0, s45, 19456
    s_add_u32 s52, s49, 77824
    buffer_load_dwordx4 v24, s[28:31], s52 offen nt lds
    s_waitcnt lgkmcnt(0)
    v_mfma_f32_32x32x16_bf16 v[224:239], v[96:99], a[96:99], v[224:239]
    v_max3_f32 v84, v84, v204, v205
    v_max3_f32 v85, v85, v220, v221
    v_max3_f32 v84, v84, v206, v207
    v_max3_f32 v85, v85, v222, v223
    v_mfma_f32_32x32x16_bf16 v[240:255], v[96:99], a[100:103], v[240:255]
    v_mul_f32 v120, s53, v84
    v_mul_f32 v122, s53, v85
    v_pk_fma_f32 v[192:193], v[192:193], s[94:95], v[120:121] op_sel_hi:[1,0,0] neg_lo:[0,0,1] neg_hi:[0,0,1]
    v_pk_fma_f32 v[208:209], v[208:209], s[94:95], v[122:123] op_sel_hi:[1,0,0] neg_lo:[0,0,1] neg_hi:[0,0,1]
    s_add_u32 m0, s45, 20480
    s_add_u32 s52, s49, 81920
    buffer_load_dwordx4 v24, s[28:31], s52 offen nt lds
    v_mfma_f32_32x32x16_bf16 v[224:239], v[100:103], a[104:107], v[224:239]
    v_exp_f32 v192, v192
    v_exp_f32 v193, v193
    v_exp_f32 v208, v208
    v_exp_f32 v209, v209
    v_mfma_f32_32x32x16_bf16 v[240:255], v[100:103], a[108:111], v[240:255]
    v_pk_fma_f32 v[194:195], v[194:195], s[94:95], v[120:121] op_sel_hi:[1,0,0] neg_lo:[0,0,1] neg_hi:[0,0,1]
    v_pk_fma_f32 v[210:211], v[210:211], s[94:95], v[122:123] op_sel_hi:[1,0,0] neg_lo:[0,0,1] neg_hi:[0,0,1]
    v_exp_f32 v194, v194
    v_exp_f32 v195, v195
    s_add_u32 m0, s45, 21504
    s_add_u32 s52, s49, 86016
    buffer_load_dwordx4 v24, s[28:31], s52 offen nt lds
    v_mfma_f32_32x32x16_bf16 v[224:239], v[104:107], a[112:115], v[224:239]
    v_exp_f32 v210, v210
    v_exp_f32 v211, v211
    v_pk_fma_f32 v[196:197], v[196:197], s[94:95], v[120:121] op_sel_hi:[1,0,0] neg_lo:[0,0,1] neg_hi:[0,0,1]
    v_pk_fma_f32 v[212:213], v[212:213], s[94:95], v[122:123] op_sel_hi:[1,0,0] neg_lo:[0,0,1] neg_hi:[0,0,1]
    v_mfma_f32_32x32x16_bf16 v[240:255], v[104:107], a[116:119], v[240:255]
    v_exp_f32 v196, v196
    v_exp_f32 v197, v197
    v_exp_f32 v212, v212
    v_exp_f32 v213, v213
    s_add_u32 m0, s45, 22528
    s_add_u32 s52, s49, 90112
    buffer_load_dwordx4 v24, s[28:31], s52 offen nt lds
    v_mfma_f32_32x32x16_bf16 v[224:239], v[108:111], a[120:123], v[224:239]
    v_pk_fma_f32 v[198:199], v[198:199], s[94:95], v[120:121] op_sel_hi:[1,0,0] neg_lo:[0,0,1] neg_hi:[0,0,1]
    v_pk_fma_f32 v[214:215], v[214:215], s[94:95], v[122:123] op_sel_hi:[1,0,0] neg_lo:[0,0,1] neg_hi:[0,0,1]
    v_exp_f32 v198, v198
    v_exp_f32 v199, v199
    v_mfma_f32_32x32x16_bf16 v[240:255], v[108:111], a[124:127], v[240:255]
    v_exp_f32 v214, v214
    v_exp_f32 v215, v215
    v_pk_fma_f32 v[200:201], v[200:201], s[94:95], v[120:121] op_sel_hi:[1,0,0] neg_lo:[0,0,1] neg_hi:[0,0,1]
    v_pk_fma_f32 v[216:217], v[216:217], s[94:95], v[122:123] op_sel_hi:[1,0,0] neg_lo:[0,0,1] neg_hi:[0,0,1]
    s_add_u32 m0, s45, 23552
    s_add_u32 s52, s49, 94208
    buffer_load_dwordx4 v24, s[28:31], s52 offen nt lds
    s_nop 15
    v_exp_f32 v200, v200
    v_exp_f32 v201, v201
    v_exp_f32 v216, v216
    v_exp_f32 v217, v217
    v_pk_fma_f32 v[202:203], v[202:203], s[94:95], v[120:121] op_sel_hi:[1,0,0] neg_lo:[0,0,1] neg_hi:[0,0,1]
    v_pk_fma_f32 v[218:219], v[218:219], s[94:95], v[122:123] op_sel_hi:[1,0,0] neg_lo:[0,0,1] neg_hi:[0,0,1]
    v_exp_f32 v202, v202
    v_exp_f32 v203, v203
    v_exp_f32 v218, v218
    v_exp_f32 v219, v219
    v_pk_fma_f32 v[204:205], v[204:205], s[94:95], v[120:121] op_sel_hi:[1,0,0] neg_lo:[0,0,1] neg_hi:[0,0,1]
    v_pk_fma_f32 v[220:221], v[220:221], s[94:95], v[122:123] op_sel_hi:[1,0,0] neg_lo:[0,0,1] neg_hi:[0,0,1]
    v_exp_f32 v204, v204
    v_exp_f32 v205, v205
    v_exp_f32 v220, v220
    v_exp_f32 v221, v221
    v_pk_fma_f32 v[206:207], v[206:207], s[94:95], v[120:121] op_sel_hi:[1,0,0] neg_lo:[0,0,1] neg_hi:[0,0,1]
    v_pk_fma_f32 v[222:223], v[222:223], s[94:95], v[122:123] op_sel_hi:[1,0,0] neg_lo:[0,0,1] neg_hi:[0,0,1]
    v_exp_f32 v206, v206
    v_exp_f32 v207, v207
    v_exp_f32 v222, v222
    v_exp_f32 v223, v223
    v_pk_add_f32 v[112:113], v[192:193], v[194:195]
    v_pk_add_f32 v[114:115], v[208:209], v[210:211]
    v_pk_add_f32 v[112:113], v[112:113], v[196:197]
    v_pk_add_f32 v[114:115], v[114:115], v[212:213]
    v_pk_add_f32 v[112:113], v[112:113], v[198:199]
    v_pk_add_f32 v[114:115], v[114:115], v[214:215]
    v_pk_add_f32 v[112:113], v[112:113], v[200:201]
    v_pk_add_f32 v[114:115], v[114:115], v[216:217]
    v_pk_add_f32 v[112:113], v[112:113], v[202:203]
    v_pk_add_f32 v[114:115], v[114:115], v[218:219]
    v_pk_add_f32 v[112:113], v[112:113], v[204:205]
    v_pk_add_f32 v[114:115], v[114:115], v[220:221]
    v_pk_add_f32 v[112:113], v[112:113], v[206:207]
    v_pk_add_f32 v[114:115], v[114:115], v[222:223]
    v_add_f32 v92, v112, v113
    v_add_f32 v93, v114, v115
    v_cvt_pk_bf16_f32 v225, v224, v225
    v_lshlrev_b32 v224, 16, v225
    v_and_b32 v225, s58, v225
    v_cvt_pk_bf16_f32 v227, v226, v227
    v_lshlrev_b32 v226, 16, v227
    v_and_b32 v227, s58, v227
    v_cvt_pk_bf16_f32 v229, v228, v229
    v_lshlrev_b32 v228, 16, v229
    v_and_b32 v229, s58, v229
    v_cvt_pk_bf16_f32 v231, v230, v231
    v_lshlrev_b32 v230, 16, v231
    v_and_b32 v231, s58, v231
    v_cvt_pk_bf16_f32 v233, v232, v233
    v_lshlrev_b32 v232, 16, v233
    v_and_b32 v233, s58, v233
    v_cvt_pk_bf16_f32 v235, v234, v235
    v_lshlrev_b32 v234, 16, v235
    v_and_b32 v235, s58, v235
    v_cvt_pk_bf16_f32 v237, v236, v237
    v_lshlrev_b32 v236, 16, v237
    v_and_b32 v237, s58, v237
    v_cvt_pk_bf16_f32 v239, v238, v239
    v_lshlrev_b32 v238, 16, v239
    v_and_b32 v239, s58, v239
    v_cvt_pk_bf16_f32 v241, v240, v241
    v_lshlrev_b32 v240, 16, v241
    v_and_b32 v241, s58, v241
    v_cvt_pk_bf16_f32 v243, v242, v243
    v_lshlrev_b32 v242, 16, v243
    v_and_b32 v243, s58, v243
    v_cvt_pk_bf16_f32 v245, v244, v245
    v_lshlrev_b32 v244, 16, v245
    v_and_b32 v245, s58, v245
    v_cvt_pk_bf16_f32 v247, v246, v247
    v_lshlrev_b32 v246, 16, v247
    v_and_b32 v247, s58, v247
    v_cvt_pk_bf16_f32 v249, v248, v249
    v_lshlrev_b32 v248, 16, v249
    v_and_b32 v249, s58, v249
    v_cvt_pk_bf16_f32 v251, v250, v251
    v_lshlrev_b32 v250, 16, v251
    v_and_b32 v251, s58, v251
    v_cvt_pk_bf16_f32 v253, v252, v253
    v_lshlrev_b32 v252, 16, v253
    v_and_b32 v253, s58, v253
    v_cvt_pk_bf16_f32 v255, v254, v255
    v_lshlrev_b32 v254, 16, v255
    v_and_b32 v255, s58, v255
    v_max_f32 v86, v224, v225
    v_max_f32 v87, v240, v241
    v_max3_f32 v86, v86, v226, v227
    v_max3_f32 v87, v87, v242, v243
    v_max3_f32 v86, v86, v228, v229
    v_max3_f32 v87, v87, v244, v245
    v_max3_f32 v86, v86, v230, v231
    v_max3_f32 v87, v87, v246, v247
    v_max3_f32 v86, v86, v232, v233
    v_max3_f32 v87, v87, v248, v249
    v_max3_f32 v86, v86, v234, v235
    v_max3_f32 v87, v87, v250, v251
    v_max3_f32 v86, v86, v236, v237
    v_max3_f32 v87, v87, v252, v253
    v_max3_f32 v86, v86, v238, v239
    v_max3_f32 v87, v87, v254, v255
    v_mul_f32 v120, s53, v86
    v_mul_f32 v122, s53, v87
    v_pk_fma_f32 v[224:225], v[224:225], s[94:95], v[120:121] op_sel_hi:[1,0,0] neg_lo:[0,0,1] neg_hi:[0,0,1]
    v_pk_fma_f32 v[240:241], v[240:241], s[94:95], v[122:123] op_sel_hi:[1,0,0] neg_lo:[0,0,1] neg_hi:[0,0,1]
    v_exp_f32 v224, v224
    v_exp_f32 v225, v225
    v_exp_f32 v240, v240
    v_exp_f32 v241, v241
    v_pk_fma_f32 v[226:227], v[226:227], s[94:95], v[120:121] op_sel_hi:[1,0,0] neg_lo:[0,0,1] neg_hi:[0,0,1]
    v_pk_fma_f32 v[242:243], v[242:243], s[94:95], v[122:123] op_sel_hi:[1,0,0] neg_lo:[0,0,1] neg_hi:[0,0,1]
    v_exp_f32 v226, v226
    v_exp_f32 v227, v227
    v_exp_f32 v242, v242
    v_exp_f32 v243, v243
    v_pk_fma_f32 v[228:229], v[228:229], s[94:95], v[120:121] op_sel_hi:[1,0,0] neg_lo:[0,0,1] neg_hi:[0,0,1]
    v_pk_fma_f32 v[244:245], v[244:245], s[94:95], v[122:123] op_sel_hi:[1,0,0] neg_lo:[0,0,1] neg_hi:[0,0,1]
    v_exp_f32 v228, v228
    v_exp_f32 v229, v229
    v_exp_f32 v244, v244
    v_exp_f32 v245, v245
    v_pk_fma_f32 v[230:231], v[230:231], s[94:95], v[120:121] op_sel_hi:[1,0,0] neg_lo:[0,0,1] neg_hi:[0,0,1]
    v_pk_fma_f32 v[246:247], v[246:247], s[94:95], v[122:123] op_sel_hi:[1,0,0] neg_lo:[0,0,1] neg_hi:[0,0,1]
    v_exp_f32 v230, v230
    v_exp_f32 v231, v231
    v_exp_f32 v246, v246
    v_exp_f32 v247, v247
    v_pk_fma_f32 v[232:233], v[232:233], s[94:95], v[120:121] op_sel_hi:[1,0,0] neg_lo:[0,0,1] neg_hi:[0,0,1]
    v_pk_fma_f32 v[248:249], v[248:249], s[94:95], v[122:123] op_sel_hi:[1,0,0] neg_lo:[0,0,1] neg_hi:[0,0,1]
    v_exp_f32 v232, v232
    v_exp_f32 v233, v233
    v_exp_f32 v248, v248
    v_exp_f32 v249, v249
    v_pk_fma_f32 v[234:235], v[234:235], s[94:95], v[120:121] op_sel_hi:[1,0,0] neg_lo:[0,0,1] neg_hi:[0,0,1]
    v_pk_fma_f32 v[250:251], v[250:251], s[94:95], v[122:123] op_sel_hi:[1,0,0] neg_lo:[0,0,1] neg_hi:[0,0,1]
    v_exp_f32 v234, v234
    v_exp_f32 v235, v235
    v_exp_f32 v250, v250
    v_exp_f32 v251, v251
    v_pk_fma_f32 v[236:237], v[236:237], s[94:95], v[120:121] op_sel_hi:[1,0,0] neg_lo:[0,0,1] neg_hi:[0,0,1]
    v_pk_fma_f32 v[252:253], v[252:253], s[94:95], v[122:123] op_sel_hi:[1,0,0] neg_lo:[0,0,1] neg_hi:[0,0,1]
    v_exp_f32 v236, v236
    v_exp_f32 v237, v237
    v_exp_f32 v252, v252
    v_exp_f32 v253, v253
    v_pk_fma_f32 v[238:239], v[238:239], s[94:95], v[120:121] op_sel_hi:[1,0,0] neg_lo:[0,0,1] neg_hi:[0,0,1]
    v_pk_fma_f32 v[254:255], v[254:255], s[94:95], v[122:123] op_sel_hi:[1,0,0] neg_lo:[0,0,1] neg_hi:[0,0,1]
    v_exp_f32 v238, v238
    v_exp_f32 v239, v239
    v_exp_f32 v254, v254
    v_exp_f32 v255, v255
    v_pk_add_f32 v[112:113], v[224:225], v[226:227]
    v_pk_add_f32 v[114:115], v[240:241], v[242:243]
    v_pk_add_f32 v[112:113], v[112:113], v[228:229]
    v_pk_add_f32 v[114:115], v[114:115], v[244:245]
    v_pk_add_f32 v[112:113], v[112:113], v[230:231]
    v_pk_add_f32 v[114:115], v[114:115], v[246:247]
    v_pk_add_f32 v[112:113], v[112:113], v[232:233]
    v_pk_add_f32 v[114:115], v[114:115], v[248:249]
    v_pk_add_f32 v[112:113], v[112:113], v[234:235]
    v_pk_add_f32 v[114:115], v[114:115], v[250:251]
    v_pk_add_f32 v[112:113], v[112:113], v[236:237]
    v_pk_add_f32 v[114:115], v[114:115], v[252:253]
    v_pk_add_f32 v[112:113], v[112:113], v[238:239]
    v_pk_add_f32 v[114:115], v[114:115], v[254:255]
    v_add_f32 v94, v112, v113
    v_add_f32 v95, v114, v115
    v_max3_f32 v40, v80, v82, v84
    v_max3_f32 v42, v81, v83, v85
    v_max_f32 v40, v40, v86
    v_max_f32 v42, v42, v87
    v_sub_f32 v46, v80, v40
    v_sub_f32 v47, v81, v42
    v_sub_f32 v48, v82, v40
    v_sub_f32 v49, v83, v42
    v_sub_f32 v50, v84, v40
    v_sub_f32 v51, v85, v42
    v_sub_f32 v52, v86, v40
    v_sub_f32 v53, v87, v42
    v_mul_f32 v46, s53, v46
    v_mul_f32 v47, s53, v47
    v_mul_f32 v48, s53, v48
    v_mul_f32 v49, s53, v49
    v_mul_f32 v50, s53, v50
    v_mul_f32 v51, s53, v51
    v_mul_f32 v52, s53, v52
    v_mul_f32 v53, s53, v53
    v_exp_f32 v46, v46
    v_exp_f32 v47, v47
    v_exp_f32 v48, v48
    v_exp_f32 v49, v49
    v_exp_f32 v50, v50
    v_exp_f32 v51, v51
    v_exp_f32 v52, v52
    v_exp_f32 v53, v53
    s_nop 0
    v_mul_f32 v41, v46, v88
    v_mul_f32 v43, v47, v89
    v_fmac_f32 v41, v48, v90
    v_fmac_f32 v43, v49, v91
    v_fmac_f32 v41, v50, v92
    v_fmac_f32 v43, v51, v93
    v_fmac_f32 v41, v52, v94
    v_fmac_f32 v43, v53, v95
    s_lshl_b32 s52, s44, 10
    s_add_u32 s52, s52, 98304
    v_lshlrev_b32 v4, 3, v2
    v_lshl_add_u32 v5, v3, 9, v4
    v_add_u32 v32, s52, v5
    v_add_u32 v33, 98304, v4
    ds_write_b64 v32, v[40:41] offset:0
    ds_write_b64 v32, v[42:43] offset:256
    s_waitcnt lgkmcnt(0)
    s_barrier
    ds_read_b64 v[96:97], v33 offset:0
    ds_read_b64 v[98:99], v33 offset:512
    ds_read_b64 v[100:101], v33 offset:1024
    ds_read_b64 v[102:103], v33 offset:1536
    ds_read_b64 v[104:105], v33 offset:2048
    ds_read_b64 v[106:107], v33 offset:2560
    ds_read_b64 v[108:109], v33 offset:3072
    ds_read_b64 v[110:111], v33 offset:3584
    s_waitcnt lgkmcnt(0)
    ds_read_b64 v[112:113], v33 offset:256
    ds_read_b64 v[114:115], v33 offset:768
    ds_read_b64 v[116:117], v33 offset:1280
    ds_read_b64 v[118:119], v33 offset:1792
    ds_read_b64 v[120:121], v33 offset:2304
    ds_read_b64 v[122:123], v33 offset:2816
    ds_read_b64 v[124:125], v33 offset:3328
    ds_read_b64 v[126:127], v33 offset:3840
    s_waitcnt lgkmcnt(0)
    s_waitcnt lgkmcnt(0)
    s_barrier
    v_max3_f32 v62, v96, v98, v100
    v_max3_f32 v62, v62, v102, v104
    v_max3_f32 v62, v62, v106, v108
    v_max_f32 v62, v62, v110
    v_sub_f32 v96, v96, v62
    v_mul_f32 v96, s53, v96
    v_exp_f32 v96, v96
    v_sub_f32 v98, v98, v62
    v_mul_f32 v98, s53, v98
    v_exp_f32 v98, v98
    v_sub_f32 v100, v100, v62
    v_mul_f32 v100, s53, v100
    v_exp_f32 v100, v100
    v_sub_f32 v102, v102, v62
    v_mul_f32 v102, s53, v102
    v_exp_f32 v102, v102
    v_sub_f32 v104, v104, v62
    v_mul_f32 v104, s53, v104
    v_exp_f32 v104, v104
    v_sub_f32 v106, v106, v62
    v_mul_f32 v106, s53, v106
    v_exp_f32 v106, v106
    v_sub_f32 v108, v108, v62
    v_mul_f32 v108, s53, v108
    v_exp_f32 v108, v108
    v_sub_f32 v110, v110, v62
    v_mul_f32 v110, s53, v110
    v_exp_f32 v110, v110
    s_nop 0
    v_mul_f32 v56, v96, v97
    v_fmac_f32 v56, v98, v99
    v_fmac_f32 v56, v100, v101
    v_fmac_f32 v56, v102, v103
    v_fmac_f32 v56, v104, v105
    v_fmac_f32 v56, v106, v107
    v_fmac_f32 v56, v108, v109
    v_fmac_f32 v56, v110, v111
    v_rcp_f32 v56, v56
    v_sub_f32 v64, v80, v62
    v_sub_f32 v68, v82, v62
    v_sub_f32 v72, v84, v62
    v_sub_f32 v76, v86, v62
    v_mul_f32 v64, s53, v64
    v_mul_f32 v68, s53, v68
    v_mul_f32 v72, s53, v72
    v_mul_f32 v76, s53, v76
    v_exp_f32 v64, v64
    v_exp_f32 v68, v68
    v_exp_f32 v72, v72
    v_exp_f32 v76, v76
    s_nop 0
    v_mul_f32 v64, v64, v56
    v_mul_f32 v68, v68, v56
    v_mul_f32 v72, v72, v56
    v_mul_f32 v76, v76, v56
    v_max3_f32 v63, v112, v114, v116
    v_max3_f32 v63, v63, v118, v120
    v_max3_f32 v63, v63, v122, v124
    v_max_f32 v63, v63, v126
    v_sub_f32 v112, v112, v63
    v_mul_f32 v112, s53, v112
    v_exp_f32 v112, v112
    v_sub_f32 v114, v114, v63
    v_mul_f32 v114, s53, v114
    v_exp_f32 v114, v114
    v_sub_f32 v116, v116, v63
    v_mul_f32 v116, s53, v116
    v_exp_f32 v116, v116
    v_sub_f32 v118, v118, v63
    v_mul_f32 v118, s53, v118
    v_exp_f32 v118, v118
    v_sub_f32 v120, v120, v63
    v_mul_f32 v120, s53, v120
    v_exp_f32 v120, v120
    v_sub_f32 v122, v122, v63
    v_mul_f32 v122, s53, v122
    v_exp_f32 v122, v122
    v_sub_f32 v124, v124, v63
    v_mul_f32 v124, s53, v124
    v_exp_f32 v124, v124
    v_sub_f32 v126, v126, v63
    v_mul_f32 v126, s53, v126
    v_exp_f32 v126, v126
    s_nop 0
    v_mul_f32 v57, v112, v113
    v_fmac_f32 v57, v114, v115
    v_fmac_f32 v57, v116, v117
    v_fmac_f32 v57, v118, v119
    v_fmac_f32 v57, v120, v121
    v_fmac_f32 v57, v122, v123
    v_fmac_f32 v57, v124, v125
    v_fmac_f32 v57, v126, v127
    v_rcp_f32 v57, v57
    v_sub_f32 v66, v81, v63
    v_sub_f32 v70, v83, v63
    v_sub_f32 v74, v85, v63
    v_sub_f32 v78, v87, v63
    v_mul_f32 v66, s53, v66
    v_mul_f32 v70, s53, v70
    v_mul_f32 v74, s53, v74
    v_mul_f32 v78, s53, v78
    v_exp_f32 v66, v66
    v_exp_f32 v70, v70
    v_exp_f32 v74, v74
    v_exp_f32 v78, v78
    s_nop 0
    v_mul_f32 v66, v66, v57
    v_mul_f32 v70, v70, v57
    v_mul_f32 v74, v74, v57
    v_mul_f32 v78, v78, v57
    s_lshl_b32 s52, s44, 8
    s_add_u32 s52, s52, 98304
    v_and_b32 v4, 15, v2
    v_lshlrev_b32 v4, 4, v4
    v_lshl_add_u32 v4, v2, 10, v4
    v_lshl_add_u32 v5, v3, 3, v4
    v_add_u32 v32, s52, v5
    v_xor_b32 v33, 0, v32
    v_pk_mul_f32 v[128:129], v[128:129], v[64:65] op_sel_hi:[1,0]
    v_pk_mul_f32 v[130:131], v[130:131], v[64:65] op_sel_hi:[1,0]
    v_cvt_pk_bf16_f32 v58, v128, v129
    v_cvt_pk_bf16_f32 v59, v130, v131
    ds_write_b64 v33, v[58:59] offset:0
    v_pk_mul_f32 v[144:145], v[144:145], v[66:67] op_sel_hi:[1,0]
    v_pk_mul_f32 v[146:147], v[146:147], v[66:67] op_sel_hi:[1,0]
    v_cvt_pk_bf16_f32 v60, v144, v145
    v_cvt_pk_bf16_f32 v61, v146, v147
    ds_write_b64 v33, v[60:61] offset:32768
    v_xor_b32 v33, 16, v32
    v_pk_mul_f32 v[132:133], v[132:133], v[64:65] op_sel_hi:[1,0]
    v_pk_mul_f32 v[134:135], v[134:135], v[64:65] op_sel_hi:[1,0]
    v_cvt_pk_bf16_f32 v58, v132, v133
    v_cvt_pk_bf16_f32 v59, v134, v135
    ds_write_b64 v33, v[58:59] offset:0
    v_pk_mul_f32 v[148:149], v[148:149], v[66:67] op_sel_hi:[1,0]
    v_pk_mul_f32 v[150:151], v[150:151], v[66:67] op_sel_hi:[1,0]
    v_cvt_pk_bf16_f32 v60, v148, v149
    v_cvt_pk_bf16_f32 v61, v150, v151
    ds_write_b64 v33, v[60:61] offset:32768
    v_xor_b32 v33, 32, v32
    v_pk_mul_f32 v[136:137], v[136:137], v[64:65] op_sel_hi:[1,0]
    v_pk_mul_f32 v[138:139], v[138:139], v[64:65] op_sel_hi:[1,0]
    v_cvt_pk_bf16_f32 v58, v136, v137
    v_cvt_pk_bf16_f32 v59, v138, v139
    ds_write_b64 v33, v[58:59] offset:0
    v_pk_mul_f32 v[152:153], v[152:153], v[66:67] op_sel_hi:[1,0]
    v_pk_mul_f32 v[154:155], v[154:155], v[66:67] op_sel_hi:[1,0]
    v_cvt_pk_bf16_f32 v60, v152, v153
    v_cvt_pk_bf16_f32 v61, v154, v155
    ds_write_b64 v33, v[60:61] offset:32768
    v_xor_b32 v33, 48, v32
    v_pk_mul_f32 v[140:141], v[140:141], v[64:65] op_sel_hi:[1,0]
    v_pk_mul_f32 v[142:143], v[142:143], v[64:65] op_sel_hi:[1,0]
    v_cvt_pk_bf16_f32 v58, v140, v141
    v_cvt_pk_bf16_f32 v59, v142, v143
    ds_write_b64 v33, v[58:59] offset:0
    v_pk_mul_f32 v[156:157], v[156:157], v[66:67] op_sel_hi:[1,0]
    v_pk_mul_f32 v[158:159], v[158:159], v[66:67] op_sel_hi:[1,0]
    v_cvt_pk_bf16_f32 v60, v156, v157
    v_cvt_pk_bf16_f32 v61, v158, v159
    ds_write_b64 v33, v[60:61] offset:32768
    v_xor_b32 v33, 64, v32
    v_pk_mul_f32 v[160:161], v[160:161], v[68:69] op_sel_hi:[1,0]
    v_pk_mul_f32 v[162:163], v[162:163], v[68:69] op_sel_hi:[1,0]
    v_cvt_pk_bf16_f32 v58, v160, v161
    v_cvt_pk_bf16_f32 v59, v162, v163
    ds_write_b64 v33, v[58:59] offset:0
    v_pk_mul_f32 v[176:177], v[176:177], v[70:71] op_sel_hi:[1,0]
    v_pk_mul_f32 v[178:179], v[178:179], v[70:71] op_sel_hi:[1,0]
    v_cvt_pk_bf16_f32 v60, v176, v177
    v_cvt_pk_bf16_f32 v61, v178, v179
    ds_write_b64 v33, v[60:61] offset:32768
    v_xor_b32 v33, 80, v32
    v_pk_mul_f32 v[164:165], v[164:165], v[68:69] op_sel_hi:[1,0]
    v_pk_mul_f32 v[166:167], v[166:167], v[68:69] op_sel_hi:[1,0]
    v_cvt_pk_bf16_f32 v58, v164, v165
    v_cvt_pk_bf16_f32 v59, v166, v167
    ds_write_b64 v33, v[58:59] offset:0
    v_pk_mul_f32 v[180:181], v[180:181], v[70:71] op_sel_hi:[1,0]
    v_pk_mul_f32 v[182:183], v[182:183], v[70:71] op_sel_hi:[1,0]
    v_cvt_pk_bf16_f32 v60, v180, v181
    v_cvt_pk_bf16_f32 v61, v182, v183
    ds_write_b64 v33, v[60:61] offset:32768
    v_xor_b32 v33, 96, v32
    v_pk_mul_f32 v[168:169], v[168:169], v[68:69] op_sel_hi:[1,0]
    v_pk_mul_f32 v[170:171], v[170:171], v[68:69] op_sel_hi:[1,0]
    v_cvt_pk_bf16_f32 v58, v168, v169
    v_cvt_pk_bf16_f32 v59, v170, v171
    ds_write_b64 v33, v[58:59] offset:0
    v_pk_mul_f32 v[184:185], v[184:185], v[70:71] op_sel_hi:[1,0]
    v_pk_mul_f32 v[186:187], v[186:187], v[70:71] op_sel_hi:[1,0]
    v_cvt_pk_bf16_f32 v60, v184, v185
    v_cvt_pk_bf16_f32 v61, v186, v187
    ds_write_b64 v33, v[60:61] offset:32768
    v_xor_b32 v33, 112, v32
    v_pk_mul_f32 v[172:173], v[172:173], v[68:69] op_sel_hi:[1,0]
    v_pk_mul_f32 v[174:175], v[174:175], v[68:69] op_sel_hi:[1,0]
    v_cvt_pk_bf16_f32 v58, v172, v173
    v_cvt_pk_bf16_f32 v59, v174, v175
    ds_write_b64 v33, v[58:59] offset:0
    v_pk_mul_f32 v[188:189], v[188:189], v[70:71] op_sel_hi:[1,0]
    v_pk_mul_f32 v[190:191], v[190:191], v[70:71] op_sel_hi:[1,0]
    v_cvt_pk_bf16_f32 v60, v188, v189
    v_cvt_pk_bf16_f32 v61, v190, v191
    ds_write_b64 v33, v[60:61] offset:32768
    v_xor_b32 v33, 128, v32
    v_pk_mul_f32 v[192:193], v[192:193], v[72:73] op_sel_hi:[1,0]
    v_pk_mul_f32 v[194:195], v[194:195], v[72:73] op_sel_hi:[1,0]
    v_cvt_pk_bf16_f32 v58, v192, v193
    v_cvt_pk_bf16_f32 v59, v194, v195
    ds_write_b64 v33, v[58:59] offset:0
    v_pk_mul_f32 v[208:209], v[208:209], v[74:75] op_sel_hi:[1,0]
    v_pk_mul_f32 v[210:211], v[210:211], v[74:75] op_sel_hi:[1,0]
    v_cvt_pk_bf16_f32 v60, v208, v209
    v_cvt_pk_bf16_f32 v61, v210, v211
    ds_write_b64 v33, v[60:61] offset:32768
    v_xor_b32 v33, 144, v32
    v_pk_mul_f32 v[196:197], v[196:197], v[72:73] op_sel_hi:[1,0]
    v_pk_mul_f32 v[198:199], v[198:199], v[72:73] op_sel_hi:[1,0]
    v_cvt_pk_bf16_f32 v58, v196, v197
    v_cvt_pk_bf16_f32 v59, v198, v199
    ds_write_b64 v33, v[58:59] offset:0
    v_pk_mul_f32 v[212:213], v[212:213], v[74:75] op_sel_hi:[1,0]
    v_pk_mul_f32 v[214:215], v[214:215], v[74:75] op_sel_hi:[1,0]
    v_cvt_pk_bf16_f32 v60, v212, v213
    v_cvt_pk_bf16_f32 v61, v214, v215
    ds_write_b64 v33, v[60:61] offset:32768
    v_xor_b32 v33, 160, v32
    v_pk_mul_f32 v[200:201], v[200:201], v[72:73] op_sel_hi:[1,0]
    v_pk_mul_f32 v[202:203], v[202:203], v[72:73] op_sel_hi:[1,0]
    v_cvt_pk_bf16_f32 v58, v200, v201
    v_cvt_pk_bf16_f32 v59, v202, v203
    ds_write_b64 v33, v[58:59] offset:0
    v_pk_mul_f32 v[216:217], v[216:217], v[74:75] op_sel_hi:[1,0]
    v_pk_mul_f32 v[218:219], v[218:219], v[74:75] op_sel_hi:[1,0]
    v_cvt_pk_bf16_f32 v60, v216, v217
    v_cvt_pk_bf16_f32 v61, v218, v219
    ds_write_b64 v33, v[60:61] offset:32768
    v_xor_b32 v33, 176, v32
    v_pk_mul_f32 v[204:205], v[204:205], v[72:73] op_sel_hi:[1,0]
    v_pk_mul_f32 v[206:207], v[206:207], v[72:73] op_sel_hi:[1,0]
    v_cvt_pk_bf16_f32 v58, v204, v205
    v_cvt_pk_bf16_f32 v59, v206, v207
    ds_write_b64 v33, v[58:59] offset:0
    v_pk_mul_f32 v[220:221], v[220:221], v[74:75] op_sel_hi:[1,0]
    v_pk_mul_f32 v[222:223], v[222:223], v[74:75] op_sel_hi:[1,0]
    v_cvt_pk_bf16_f32 v60, v220, v221
    v_cvt_pk_bf16_f32 v61, v222, v223
    ds_write_b64 v33, v[60:61] offset:32768
    v_xor_b32 v33, 192, v32
    v_pk_mul_f32 v[224:225], v[224:225], v[76:77] op_sel_hi:[1,0]
    v_pk_mul_f32 v[226:227], v[226:227], v[76:77] op_sel_hi:[1,0]
    v_cvt_pk_bf16_f32 v58, v224, v225
    v_cvt_pk_bf16_f32 v59, v226, v227
    ds_write_b64 v33, v[58:59] offset:0
    v_pk_mul_f32 v[240:241], v[240:241], v[78:79] op_sel_hi:[1,0]
    v_pk_mul_f32 v[242:243], v[242:243], v[78:79] op_sel_hi:[1,0]
    v_cvt_pk_bf16_f32 v60, v240, v241
    v_cvt_pk_bf16_f32 v61, v242, v243
    ds_write_b64 v33, v[60:61] offset:32768
    v_xor_b32 v33, 208, v32
    v_pk_mul_f32 v[228:229], v[228:229], v[76:77] op_sel_hi:[1,0]
    v_pk_mul_f32 v[230:231], v[230:231], v[76:77] op_sel_hi:[1,0]
    v_cvt_pk_bf16_f32 v58, v228, v229
    v_cvt_pk_bf16_f32 v59, v230, v231
    ds_write_b64 v33, v[58:59] offset:0
    v_pk_mul_f32 v[244:245], v[244:245], v[78:79] op_sel_hi:[1,0]
    v_pk_mul_f32 v[246:247], v[246:247], v[78:79] op_sel_hi:[1,0]
    v_cvt_pk_bf16_f32 v60, v244, v245
    v_cvt_pk_bf16_f32 v61, v246, v247
    ds_write_b64 v33, v[60:61] offset:32768
    v_xor_b32 v33, 224, v32
    v_pk_mul_f32 v[232:233], v[232:233], v[76:77] op_sel_hi:[1,0]
    v_pk_mul_f32 v[234:235], v[234:235], v[76:77] op_sel_hi:[1,0]
    v_cvt_pk_bf16_f32 v58, v232, v233
    v_cvt_pk_bf16_f32 v59, v234, v235
    ds_write_b64 v33, v[58:59] offset:0
    v_pk_mul_f32 v[248:249], v[248:249], v[78:79] op_sel_hi:[1,0]
    v_pk_mul_f32 v[250:251], v[250:251], v[78:79] op_sel_hi:[1,0]
    v_cvt_pk_bf16_f32 v60, v248, v249
    v_cvt_pk_bf16_f32 v61, v250, v251
    ds_write_b64 v33, v[60:61] offset:32768
    v_xor_b32 v33, 240, v32
    v_pk_mul_f32 v[236:237], v[236:237], v[76:77] op_sel_hi:[1,0]
    v_pk_mul_f32 v[238:239], v[238:239], v[76:77] op_sel_hi:[1,0]
    v_cvt_pk_bf16_f32 v58, v236, v237
    v_cvt_pk_bf16_f32 v59, v238, v239
    ds_write_b64 v33, v[58:59] offset:0
    v_pk_mul_f32 v[252:253], v[252:253], v[78:79] op_sel_hi:[1,0]
    v_pk_mul_f32 v[254:255], v[254:255], v[78:79] op_sel_hi:[1,0]
    v_cvt_pk_bf16_f32 v60, v252, v253
    v_cvt_pk_bf16_f32 v61, v254, v255
    ds_write_b64 v33, v[60:61] offset:32768
    v_and_b32 v4, 15, v2
    v_xor_b32 v4, v3, v4
    v_lshlrev_b32 v4, 4, v4
    v_lshl_add_u32 v4, v2, 10, v4
    v_add_u32 v34, 98304, v4
    s_waitcnt lgkmcnt(0)
    v_xor_b32 v40, 0, v34
    v_xor_b32 v41, 32, v34
    v_xor_b32 v42, 64, v34
    v_xor_b32 v43, 96, v34
    v_xor_b32 v44, 128, v34
    v_xor_b32 v45, 160, v34
    v_xor_b32 v46, 192, v34
    v_xor_b32 v47, 224, v34
    s_barrier
    s_waitcnt vmcnt(20)
    ds_read_b64_tr_b16 v[64:65], v16 offset:0
    ds_read_b64_tr_b16 v[66:67], v16 offset:512
    ds_read_b64_tr_b16 v[68:69], v17 offset:0
    ds_read_b64_tr_b16 v[70:71], v17 offset:512
    ds_read_b128 v[80:83], v40 offset:0
    ds_read_b128 v[84:87], v40 offset:32768
    ds_read_b64_tr_b16 v[72:73], v16 offset:2048
    ds_read_b64_tr_b16 v[74:75], v16 offset:2560
    ds_read_b64_tr_b16 v[76:77], v17 offset:2048
    ds_read_b64_tr_b16 v[78:79], v17 offset:2560
    ds_read_b128 v[88:91], v41 offset:0
    ds_read_b128 v[92:95], v41 offset:32768
    s_waitcnt lgkmcnt(0)
    v_mfma_f32_32x32x16_bf16 v[128:143], v[64:67], v[80:83], 0
    v_mfma_f32_32x32x16_bf16 v[144:159], v[64:67], v[84:87], 0
    s_add_u32 m0, s45, 0
    s_add_u32 s52, s49, 98304
    buffer_load_dwordx4 v24, s[28:31], s52 offen nt lds
    v_mfma_f32_32x32x16_bf16 v[160:175], v[68:71], v[80:83], 0
    v_mfma_f32_32x32x16_bf16 v[176:191], v[68:71], v[84:87], 0
    s_add_u32 m0, s45, 1024
    s_add_u32 s52, s49, 102400
    buffer_load_dwordx4 v24, s[28:31], s52 offen nt lds
    s_waitcnt vmcnt(18)
    ds_read_b64_tr_b16 v[96:97], v16 offset:4096
    ds_read_b64_tr_b16 v[98:99], v16 offset:4608
    ds_read_b64_tr_b16 v[100:101], v17 offset:4096
    ds_read_b64_tr_b16 v[102:103], v17 offset:4608
    ds_read_b128 v[112:115], v42 offset:0
    ds_read_b128 v[116:119], v42 offset:32768
    ds_read_b64_tr_b16 v[104:105], v16 offset:6144
    ds_read_b64_tr_b16 v[106:107], v16 offset:6656
    ds_read_b64_tr_b16 v[108:109], v17 offset:6144
    ds_read_b64_tr_b16 v[110:111], v17 offset:6656
    ds_read_b128 v[120:123], v43 offset:0
    ds_read_b128 v[124:127], v43 offset:32768
    v_mfma_f32_32x32x16_bf16 v[128:143], v[72:75], v[88:91], v[128:143]
    v_mfma_f32_32x32x16_bf16 v[144:159], v[72:75], v[92:95], v[144:159]
    s_add_u32 m0, s45, 2048
    s_add_u32 s52, s49, 106496
    buffer_load_dwordx4 v24, s[28:31], s52 offen nt lds
    v_mfma_f32_32x32x16_bf16 v[160:175], v[76:79], v[88:91], v[160:175]
    v_mfma_f32_32x32x16_bf16 v[176:191], v[76:79], v[92:95], v[176:191]
    s_add_u32 m0, s45, 3072
    s_add_u32 s52, s49, 110592
    buffer_load_dwordx4 v24, s[28:31], s52 offen nt lds
    s_waitcnt lgkmcnt(0)
    v_mfma_f32_32x32x16_bf16 v[128:143], v[96:99], v[112:115], v[128:143]
    v_mfma_f32_32x32x16_bf16 v[144:159], v[96:99], v[116:119], v[144:159]
    s_add_u32 m0, s45, 4096
    s_add_u32 s52, s49, 114688
    buffer_load_dwordx4 v24, s[28:31], s52 offen nt lds
    v_mfma_f32_32x32x16_bf16 v[160:175], v[100:103], v[112:115], v[160:175]
    v_mfma_f32_32x32x16_bf16 v[176:191], v[100:103], v[116:119], v[176:191]
    s_add_u32 m0, s45, 5120
    s_add_u32 s52, s49, 118784
    buffer_load_dwordx4 v24, s[28:31], s52 offen nt lds
    s_waitcnt vmcnt(18)
    ds_read_b64_tr_b16 v[64:65], v16 offset:8192
    ds_read_b64_tr_b16 v[66:67], v16 offset:8704
    ds_read_b64_tr_b16 v[68:69], v17 offset:8192
    ds_read_b64_tr_b16 v[70:71], v17 offset:8704
    ds_read_b128 v[80:83], v44 offset:0
    ds_read_b128 v[84:87], v44 offset:32768
    ds_read_b64_tr_b16 v[72:73], v16 offset:10240
    ds_read_b64_tr_b16 v[74:75], v16 offset:10752
    ds_read_b64_tr_b16 v[76:77], v17 offset:10240
    ds_read_b64_tr_b16 v[78:79], v17 offset:10752
    ds_read_b128 v[88:91], v45 offset:0
    ds_read_b128 v[92:95], v45 offset:32768
    v_mfma_f32_32x32x16_bf16 v[128:143], v[104:107], v[120:123], v[128:143]
    v_mfma_f32_32x32x16_bf16 v[144:159], v[104:107], v[124:127], v[144:159]
    s_add_u32 m0, s45, 6144
    s_add_u32 s52, s49, 122880
    buffer_load_dwordx4 v24, s[28:31], s52 offen nt lds
    v_mfma_f32_32x32x16_bf16 v[160:175], v[108:111], v[120:123], v[160:175]
    v_mfma_f32_32x32x16_bf16 v[176:191], v[108:111], v[124:127], v[176:191]
    s_add_u32 m0, s45, 7168
    s_add_u32 s52, s49, 126976
    buffer_load_dwordx4 v24, s[28:31], s52 offen nt lds
    s_waitcnt lgkmcnt(0)
    v_mfma_f32_32x32x16_bf16 v[128:143], v[64:67], v[80:83], v[128:143]
    v_mfma_f32_32x32x16_bf16 v[144:159], v[64:67], v[84:87], v[144:159]
    s_add_u32 m0, s45, 8192
    s_add_u32 s52, s49, 131072
    buffer_load_dwordx4 v24, s[28:31], s52 offen nt lds
    v_mfma_f32_32x32x16_bf16 v[160:175], v[68:71], v[80:83], v[160:175]
    v_mfma_f32_32x32x16_bf16 v[176:191], v[68:71], v[84:87], v[176:191]
    s_add_u32 m0, s45, 9216
    s_add_u32 s52, s49, 135168
    buffer_load_dwordx4 v24, s[28:31], s52 offen nt lds
    s_waitcnt vmcnt(18)
    ds_read_b64_tr_b16 v[96:97], v16 offset:12288
    ds_read_b64_tr_b16 v[98:99], v16 offset:12800
    ds_read_b64_tr_b16 v[100:101], v17 offset:12288
    ds_read_b64_tr_b16 v[102:103], v17 offset:12800
    ds_read_b128 v[112:115], v46 offset:0
    ds_read_b128 v[116:119], v46 offset:32768
    ds_read_b64_tr_b16 v[104:105], v16 offset:14336
    ds_read_b64_tr_b16 v[106:107], v16 offset:14848
    ds_read_b64_tr_b16 v[108:109], v17 offset:14336
    ds_read_b64_tr_b16 v[110:111], v17 offset:14848
    ds_read_b128 v[120:123], v47 offset:0
    ds_read_b128 v[124:127], v47 offset:32768
    v_mfma_f32_32x32x16_bf16 v[128:143], v[72:75], v[88:91], v[128:143]
    v_mfma_f32_32x32x16_bf16 v[144:159], v[72:75], v[92:95], v[144:159]
    s_add_u32 m0, s45, 10240
    s_add_u32 s52, s49, 139264
    buffer_load_dwordx4 v24, s[28:31], s52 offen nt lds
    v_mfma_f32_32x32x16_bf16 v[160:175], v[76:79], v[88:91], v[160:175]
    v_mfma_f32_32x32x16_bf16 v[176:191], v[76:79], v[92:95], v[176:191]
    s_add_u32 m0, s45, 11264
    s_add_u32 s52, s49, 143360
    buffer_load_dwordx4 v24, s[28:31], s52 offen nt lds
    s_waitcnt lgkmcnt(0)
    v_mfma_f32_32x32x16_bf16 v[128:143], v[96:99], v[112:115], v[128:143]
    v_mfma_f32_32x32x16_bf16 v[144:159], v[96:99], v[116:119], v[144:159]
    s_add_u32 m0, s45, 12288
    s_add_u32 s52, s49, 147456
    buffer_load_dwordx4 v24, s[28:31], s52 offen nt lds
    v_mfma_f32_32x32x16_bf16 v[160:175], v[100:103], v[112:115], v[160:175]
    v_mfma_f32_32x32x16_bf16 v[176:191], v[100:103], v[116:119], v[176:191]
    s_add_u32 m0, s45, 13312
    s_add_u32 s52, s49, 151552
    buffer_load_dwordx4 v24, s[28:31], s52 offen nt lds
    s_waitcnt vmcnt(18)
    ds_read_b64_tr_b16 v[64:65], v16 offset:16384
    ds_read_b64_tr_b16 v[66:67], v16 offset:16896
    ds_read_b64_tr_b16 v[68:69], v17 offset:16384
    ds_read_b64_tr_b16 v[70:71], v17 offset:16896
    ds_read_b128 v[80:83], v40 offset:256
    ds_read_b128 v[84:87], v40 offset:33024
    ds_read_b64_tr_b16 v[72:73], v16 offset:18432
    ds_read_b64_tr_b16 v[74:75], v16 offset:18944
    ds_read_b64_tr_b16 v[76:77], v17 offset:18432
    ds_read_b64_tr_b16 v[78:79], v17 offset:18944
    ds_read_b128 v[88:91], v41 offset:256
    ds_read_b128 v[92:95], v41 offset:33024
    v_mfma_f32_32x32x16_bf16 v[128:143], v[104:107], v[120:123], v[128:143]
    v_mfma_f32_32x32x16_bf16 v[144:159], v[104:107], v[124:127], v[144:159]
    s_add_u32 m0, s45, 14336
    s_add_u32 s52, s49, 155648
    buffer_load_dwordx4 v24, s[28:31], s52 offen nt lds
    v_mfma_f32_32x32x16_bf16 v[160:175], v[108:111], v[120:123], v[160:175]
    v_mfma_f32_32x32x16_bf16 v[176:191], v[108:111], v[124:127], v[176:191]
    s_add_u32 m0, s45, 15360
    s_add_u32 s52, s49, 159744
    buffer_load_dwordx4 v24, s[28:31], s52 offen nt lds
    s_waitcnt lgkmcnt(0)
    v_mfma_f32_32x32x16_bf16 v[128:143], v[64:67], v[80:83], v[128:143]
    v_mfma_f32_32x32x16_bf16 v[144:159], v[64:67], v[84:87], v[144:159]
    s_add_u32 m0, s45, 16384
    s_add_u32 s52, s49, 163840
    buffer_load_dwordx4 v24, s[28:31], s52 offen nt lds
    v_mfma_f32_32x32x16_bf16 v[160:175], v[68:71], v[80:83], v[160:175]
    v_mfma_f32_32x32x16_bf16 v[176:191], v[68:71], v[84:87], v[176:191]
    s_add_u32 m0, s45, 17408
    s_add_u32 s52, s49, 167936
    buffer_load_dwordx4 v24, s[28:31], s52 offen nt lds
    s_waitcnt vmcnt(18)
    ds_read_b64_tr_b16 v[96:97], v16 offset:20480
    ds_read_b64_tr_b16 v[98:99], v16 offset:20992
    ds_read_b64_tr_b16 v[100:101], v17 offset:20480
    ds_read_b64_tr_b16 v[102:103], v17 offset:20992
    ds_read_b128 v[112:115], v42 offset:256
    ds_read_b128 v[116:119], v42 offset:33024
    ds_read_b64_tr_b16 v[104:105], v16 offset:22528
    ds_read_b64_tr_b16 v[106:107], v16 offset:23040
    ds_read_b64_tr_b16 v[108:109], v17 offset:22528
    ds_read_b64_tr_b16 v[110:111], v17 offset:23040
    ds_read_b128 v[120:123], v43 offset:256
    ds_read_b128 v[124:127], v43 offset:33024
    v_mfma_f32_32x32x16_bf16 v[128:143], v[72:75], v[88:91], v[128:143]
    v_mfma_f32_32x32x16_bf16 v[144:159], v[72:75], v[92:95], v[144:159]
    s_add_u32 m0, s45, 18432
    s_add_u32 s52, s49, 172032
    buffer_load_dwordx4 v24, s[28:31], s52 offen nt lds
    v_mfma_f32_32x32x16_bf16 v[160:175], v[76:79], v[88:91], v[160:175]
    v_mfma_f32_32x32x16_bf16 v[176:191], v[76:79], v[92:95], v[176:191]
    s_add_u32 m0, s45, 19456
    s_add_u32 s52, s49, 176128
    buffer_load_dwordx4 v24, s[28:31], s52 offen nt lds
    s_waitcnt lgkmcnt(0)
    v_mfma_f32_32x32x16_bf16 v[128:143], v[96:99], v[112:115], v[128:143]
    v_mfma_f32_32x32x16_bf16 v[144:159], v[96:99], v[116:119], v[144:159]
    s_add_u32 m0, s45, 20480
    s_add_u32 s52, s49, 180224
    buffer_load_dwordx4 v24, s[28:31], s52 offen nt lds
    v_mfma_f32_32x32x16_bf16 v[160:175], v[100:103], v[112:115], v[160:175]
    v_mfma_f32_32x32x16_bf16 v[176:191], v[100:103], v[116:119], v[176:191]
    s_add_u32 m0, s45, 21504
    s_add_u32 s52, s49, 184320
    buffer_load_dwordx4 v24, s[28:31], s52 offen nt lds
    s_waitcnt vmcnt(18)
    ds_read_b64_tr_b16 v[64:65], v16 offset:0
    ds_read_b64_tr_b16 v[66:67], v16 offset:512
    ds_read_b64_tr_b16 v[68:69], v17 offset:0
    ds_read_b64_tr_b16 v[70:71], v17 offset:512
    ds_read_b128 v[80:83], v44 offset:256
    ds_read_b128 v[84:87], v44 offset:33024
    ds_read_b64_tr_b16 v[72:73], v16 offset:2048
    ds_read_b64_tr_b16 v[74:75], v16 offset:2560
    ds_read_b64_tr_b16 v[76:77], v17 offset:2048
    ds_read_b64_tr_b16 v[78:79], v17 offset:2560
    ds_read_b128 v[88:91], v45 offset:256
    ds_read_b128 v[92:95], v45 offset:33024
    v_mfma_f32_32x32x16_bf16 v[128:143], v[104:107], v[120:123], v[128:143]
    v_mfma_f32_32x32x16_bf16 v[144:159], v[104:107], v[124:127], v[144:159]
    s_add_u32 m0, s45, 22528
    s_add_u32 s52, s49, 188416
    buffer_load_dwordx4 v24, s[28:31], s52 offen nt lds
    v_mfma_f32_32x32x16_bf16 v[160:175], v[108:111], v[120:123], v[160:175]
    v_mfma_f32_32x32x16_bf16 v[176:191], v[108:111], v[124:127], v[176:191]
    s_add_u32 m0, s45, 23552
    s_add_u32 s52, s49, 192512
    buffer_load_dwordx4 v24, s[28:31], s52 offen nt lds
    s_waitcnt lgkmcnt(0)
    v_mfma_f32_32x32x16_bf16 v[128:143], v[64:67], v[80:83], v[128:143]
    v_mfma_f32_32x32x16_bf16 v[144:159], v[64:67], v[84:87], v[144:159]
    s_add_u32 m0, s45, 0
    s_add_u32 s52, s49, 196608
    buffer_load_dwordx4 v24, s[28:31], s52 offen nt lds
    v_mfma_f32_32x32x16_bf16 v[160:175], v[68:71], v[80:83], v[160:175]
    v_mfma_f32_32x32x16_bf16 v[176:191], v[68:71], v[84:87], v[176:191]
    s_add_u32 m0, s45, 1024
    s_add_u32 s52, s49, 200704
    buffer_load_dwordx4 v24, s[28:31], s52 offen nt lds
    s_waitcnt vmcnt(18)
    ds_read_b64_tr_b16 v[96:97], v16 offset:4096
    ds_read_b64_tr_b16 v[98:99], v16 offset:4608
    ds_read_b64_tr_b16 v[100:101], v17 offset:4096
    ds_read_b64_tr_b16 v[102:103], v17 offset:4608
    ds_read_b128 v[112:115], v46 offset:256
    ds_read_b128 v[116:119], v46 offset:33024
    ds_read_b64_tr_b16 v[104:105], v16 offset:6144
    ds_read_b64_tr_b16 v[106:107], v16 offset:6656
    ds_read_b64_tr_b16 v[108:109], v17 offset:6144
    ds_read_b64_tr_b16 v[110:111], v17 offset:6656
    ds_read_b128 v[120:123], v47 offset:256
    ds_read_b128 v[124:127], v47 offset:33024
    v_mfma_f32_32x32x16_bf16 v[128:143], v[72:75], v[88:91], v[128:143]
    v_mfma_f32_32x32x16_bf16 v[144:159], v[72:75], v[92:95], v[144:159]
    s_add_u32 m0, s45, 2048
    s_add_u32 s52, s49, 204800
    buffer_load_dwordx4 v24, s[28:31], s52 offen nt lds
    v_mfma_f32_32x32x16_bf16 v[160:175], v[76:79], v[88:91], v[160:175]
    v_mfma_f32_32x32x16_bf16 v[176:191], v[76:79], v[92:95], v[176:191]
    s_add_u32 m0, s45, 3072
    s_add_u32 s52, s49, 208896
    buffer_load_dwordx4 v24, s[28:31], s52 offen nt lds
    s_waitcnt lgkmcnt(0)
    v_mfma_f32_32x32x16_bf16 v[128:143], v[96:99], v[112:115], v[128:143]
    v_mfma_f32_32x32x16_bf16 v[144:159], v[96:99], v[116:119], v[144:159]
    s_add_u32 m0, s45, 4096
    s_add_u32 s52, s49, 212992
    buffer_load_dwordx4 v24, s[28:31], s52 offen nt lds
    v_mfma_f32_32x32x16_bf16 v[160:175], v[100:103], v[112:115], v[160:175]
    v_mfma_f32_32x32x16_bf16 v[176:191], v[100:103], v[116:119], v[176:191]
    s_add_u32 m0, s45, 5120
    s_add_u32 s52, s49, 217088
    buffer_load_dwordx4 v24, s[28:31], s52 offen nt lds
    s_waitcnt vmcnt(18)
    ds_read_b64_tr_b16 v[64:65], v16 offset:8192
    ds_read_b64_tr_b16 v[66:67], v16 offset:8704
    ds_read_b64_tr_b16 v[68:69], v17 offset:8192
    ds_read_b64_tr_b16 v[70:71], v17 offset:8704
    ds_read_b128 v[80:83], v40 offset:512
    ds_read_b128 v[84:87], v40 offset:33280
    ds_read_b64_tr_b16 v[72:73], v16 offset:10240
    ds_read_b64_tr_b16 v[74:75], v16 offset:10752
    ds_read_b64_tr_b16 v[76:77], v17 offset:10240
    ds_read_b64_tr_b16 v[78:79], v17 offset:10752
    ds_read_b128 v[88:91], v41 offset:512
    ds_read_b128 v[92:95], v41 offset:33280
    v_mfma_f32_32x32x16_bf16 v[128:143], v[104:107], v[120:123], v[128:143]
    v_mfma_f32_32x32x16_bf16 v[144:159], v[104:107], v[124:127], v[144:159]
    s_add_u32 m0, s45, 6144
    s_add_u32 s52, s49, 221184
    buffer_load_dwordx4 v24, s[28:31], s52 offen nt lds
    v_mfma_f32_32x32x16_bf16 v[160:175], v[108:111], v[120:123], v[160:175]
    v_mfma_f32_32x32x16_bf16 v[176:191], v[108:111], v[124:127], v[176:191]
    s_add_u32 m0, s45, 7168
    s_add_u32 s52, s49, 225280
    buffer_load_dwordx4 v24, s[28:31], s52 offen nt lds
    s_waitcnt lgkmcnt(0)
    v_mfma_f32_32x32x16_bf16 v[128:143], v[64:67], v[80:83], v[128:143]
    v_mfma_f32_32x32x16_bf16 v[144:159], v[64:67], v[84:87], v[144:159]
    s_add_u32 m0, s45, 8192
    s_add_u32 s52, s49, 229376
    buffer_load_dwordx4 v24, s[28:31], s52 offen nt lds
    v_mfma_f32_32x32x16_bf16 v[160:175], v[68:71], v[80:83], v[160:175]
    v_mfma_f32_32x32x16_bf16 v[176:191], v[68:71], v[84:87], v[176:191]
    s_add_u32 m0, s45, 9216
    s_add_u32 s52, s49, 233472
    buffer_load_dwordx4 v24, s[28:31], s52 offen nt lds
    s_waitcnt vmcnt(18)
    ds_read_b64_tr_b16 v[96:97], v16 offset:12288
    ds_read_b64_tr_b16 v[98:99], v16 offset:12800
    ds_read_b64_tr_b16 v[100:101], v17 offset:12288
    ds_read_b64_tr_b16 v[102:103], v17 offset:12800
    ds_read_b128 v[112:115], v42 offset:512
    ds_read_b128 v[116:119], v42 offset:33280
    ds_read_b64_tr_b16 v[104:105], v16 offset:14336
    ds_read_b64_tr_b16 v[106:107], v16 offset:14848
    ds_read_b64_tr_b16 v[108:109], v17 offset:14336
    ds_read_b64_tr_b16 v[110:111], v17 offset:14848
    ds_read_b128 v[120:123], v43 offset:512
    ds_read_b128 v[124:127], v43 offset:33280
    v_mfma_f32_32x32x16_bf16 v[128:143], v[72:75], v[88:91], v[128:143]
    v_mfma_f32_32x32x16_bf16 v[144:159], v[72:75], v[92:95], v[144:159]
    s_add_u32 m0, s45, 10240
    s_add_u32 s52, s49, 237568
    buffer_load_dwordx4 v24, s[28:31], s52 offen nt lds
    v_mfma_f32_32x32x16_bf16 v[160:175], v[76:79], v[88:91], v[160:175]
    v_mfma_f32_32x32x16_bf16 v[176:191], v[76:79], v[92:95], v[176:191]
    s_add_u32 m0, s45, 11264
    s_add_u32 s52, s49, 241664
    buffer_load_dwordx4 v24, s[28:31], s52 offen nt lds
    s_waitcnt lgkmcnt(0)
    v_mfma_f32_32x32x16_bf16 v[128:143], v[96:99], v[112:115], v[128:143]
    v_mfma_f32_32x32x16_bf16 v[144:159], v[96:99], v[116:119], v[144:159]
    s_add_u32 m0, s45, 12288
    s_add_u32 s52, s49, 245760
    buffer_load_dwordx4 v24, s[28:31], s52 offen nt lds
    v_mfma_f32_32x32x16_bf16 v[160:175], v[100:103], v[112:115], v[160:175]
    v_mfma_f32_32x32x16_bf16 v[176:191], v[100:103], v[116:119], v[176:191]
    s_add_u32 m0, s45, 13312
    s_add_u32 s52, s49, 249856
    buffer_load_dwordx4 v24, s[28:31], s52 offen nt lds
    s_waitcnt vmcnt(18)
    ds_read_b64_tr_b16 v[64:65], v16 offset:16384
    ds_read_b64_tr_b16 v[66:67], v16 offset:16896
    ds_read_b64_tr_b16 v[68:69], v17 offset:16384
    ds_read_b64_tr_b16 v[70:71], v17 offset:16896
    ds_read_b128 v[80:83], v44 offset:512
    ds_read_b128 v[84:87], v44 offset:33280
    ds_read_b64_tr_b16 v[72:73], v16 offset:18432
    ds_read_b64_tr_b16 v[74:75], v16 offset:18944
    ds_read_b64_tr_b16 v[76:77], v17 offset:18432
    ds_read_b64_tr_b16 v[78:79], v17 offset:18944
    ds_read_b128 v[88:91], v45 offset:512
    ds_read_b128 v[92:95], v45 offset:33280
    v_mfma_f32_32x32x16_bf16 v[128:143], v[104:107], v[120:123], v[128:143]
    v_mfma_f32_32x32x16_bf16 v[144:159], v[104:107], v[124:127], v[144:159]
    s_add_u32 m0, s45, 14336
    s_add_u32 s52, s49, 253952
    buffer_load_dwordx4 v24, s[28:31], s52 offen nt lds
    v_mfma_f32_32x32x16_bf16 v[160:175], v[108:111], v[120:123], v[160:175]
    v_mfma_f32_32x32x16_bf16 v[176:191], v[108:111], v[124:127], v[176:191]
    s_add_u32 m0, s45, 15360
    s_add_u32 s52, s49, 258048
    buffer_load_dwordx4 v24, s[28:31], s52 offen nt lds
    s_waitcnt lgkmcnt(0)
    v_mfma_f32_32x32x16_bf16 v[128:143], v[64:67], v[80:83], v[128:143]
    v_mfma_f32_32x32x16_bf16 v[144:159], v[64:67], v[84:87], v[144:159]
    v_mfma_f32_32x32x16_bf16 v[160:175], v[68:71], v[80:83], v[160:175]
    v_mfma_f32_32x32x16_bf16 v[176:191], v[68:71], v[84:87], v[176:191]
    s_waitcnt vmcnt(16)
    ds_read_b64_tr_b16 v[96:97], v16 offset:20480
    ds_read_b64_tr_b16 v[98:99], v16 offset:20992
    ds_read_b64_tr_b16 v[100:101], v17 offset:20480
    ds_read_b64_tr_b16 v[102:103], v17 offset:20992
    ds_read_b128 v[112:115], v46 offset:512
    ds_read_b128 v[116:119], v46 offset:33280
    ds_read_b64_tr_b16 v[104:105], v16 offset:22528
    ds_read_b64_tr_b16 v[106:107], v16 offset:23040
    ds_read_b64_tr_b16 v[108:109], v17 offset:22528
    ds_read_b64_tr_b16 v[110:111], v17 offset:23040
    ds_read_b128 v[120:123], v47 offset:512
    ds_read_b128 v[124:127], v47 offset:33280
    v_mfma_f32_32x32x16_bf16 v[128:143], v[72:75], v[88:91], v[128:143]
    v_mfma_f32_32x32x16_bf16 v[144:159], v[72:75], v[92:95], v[144:159]
    v_mfma_f32_32x32x16_bf16 v[160:175], v[76:79], v[88:91], v[160:175]
    v_mfma_f32_32x32x16_bf16 v[176:191], v[76:79], v[92:95], v[176:191]
    s_waitcnt lgkmcnt(0)
    v_mfma_f32_32x32x16_bf16 v[128:143], v[96:99], v[112:115], v[128:143]
    v_mfma_f32_32x32x16_bf16 v[144:159], v[96:99], v[116:119], v[144:159]
    s_add_u32 m0, s45, 16384
    s_add_u32 s52, s50, 0
    buffer_load_dwordx4 v25, s[36:39], s52 offen lds
    v_mfma_f32_32x32x16_bf16 v[160:175], v[100:103], v[112:115], v[160:175]
    v_mfma_f32_32x32x16_bf16 v[176:191], v[100:103], v[116:119], v[176:191]
    s_add_u32 m0, s45, 17408
    s_add_u32 s52, s50, 0
    buffer_load_dwordx4 v26, s[36:39], s52 offen lds
    s_waitcnt vmcnt(14)
    ds_read_b64_tr_b16 v[64:65], v16 offset:0
    ds_read_b64_tr_b16 v[66:67], v16 offset:512
    ds_read_b64_tr_b16 v[68:69], v17 offset:0
    ds_read_b64_tr_b16 v[70:71], v17 offset:512
    ds_read_b128 v[80:83], v40 offset:768
    ds_read_b128 v[84:87], v40 offset:33536
    ds_read_b64_tr_b16 v[72:73], v16 offset:2048
    ds_read_b64_tr_b16 v[74:75], v16 offset:2560
    ds_read_b64_tr_b16 v[76:77], v17 offset:2048
    ds_read_b64_tr_b16 v[78:79], v17 offset:2560
    ds_read_b128 v[88:91], v41 offset:768
    ds_read_b128 v[92:95], v41 offset:33536
    v_mfma_f32_32x32x16_bf16 v[128:143], v[104:107], v[120:123], v[128:143]
    v_mfma_f32_32x32x16_bf16 v[144:159], v[104:107], v[124:127], v[144:159]
    s_add_u32 m0, s45, 18432
    s_add_u32 s52, s50, 0
    buffer_load_dwordx4 v27, s[36:39], s52 offen lds
    v_mfma_f32_32x32x16_bf16 v[160:175], v[108:111], v[120:123], v[160:175]
    v_mfma_f32_32x32x16_bf16 v[176:191], v[108:111], v[124:127], v[176:191]
    s_add_u32 m0, s45, 19456
    s_add_u32 s52, s50, 0
    buffer_load_dwordx4 v28, s[36:39], s52 offen lds
    s_waitcnt lgkmcnt(0)
    v_mfma_f32_32x32x16_bf16 v[128:143], v[64:67], v[80:83], v[128:143]
    v_mfma_f32_32x32x16_bf16 v[144:159], v[64:67], v[84:87], v[144:159]
    s_add_u32 m0, s45, 20480
    s_add_u32 s52, s50, 0
    buffer_load_dwordx4 v29, s[36:39], s52 offen lds
    v_mfma_f32_32x32x16_bf16 v[160:175], v[68:71], v[80:83], v[160:175]
    v_mfma_f32_32x32x16_bf16 v[176:191], v[68:71], v[84:87], v[176:191]
    s_add_u32 m0, s45, 21504
    s_add_u32 s52, s50, 0
    buffer_load_dwordx4 v30, s[36:39], s52 offen lds
    s_waitcnt vmcnt(14)
    ds_read_b64_tr_b16 v[96:97], v16 offset:4096
    ds_read_b64_tr_b16 v[98:99], v16 offset:4608
    ds_read_b64_tr_b16 v[100:101], v17 offset:4096
    ds_read_b64_tr_b16 v[102:103], v17 offset:4608
    ds_read_b128 v[112:115], v42 offset:768
    ds_read_b128 v[116:119], v42 offset:33536
    ds_read_b64_tr_b16 v[104:105], v16 offset:6144
    ds_read_b64_tr_b16 v[106:107], v16 offset:6656
    ds_read_b64_tr_b16 v[108:109], v17 offset:6144
    ds_read_b64_tr_b16 v[110:111], v17 offset:6656
    ds_read_b128 v[120:123], v43 offset:768
    ds_read_b128 v[124:127], v43 offset:33536
    v_mfma_f32_32x32x16_bf16 v[128:143], v[72:75], v[88:91], v[128:143]
    v_mfma_f32_32x32x16_bf16 v[144:159], v[72:75], v[92:95], v[144:159]
    s_add_u32 m0, s45, 22528
    s_add_u32 s52, s50, 0
    buffer_load_dwordx4 v31, s[36:39], s52 offen lds
    v_mfma_f32_32x32x16_bf16 v[160:175], v[76:79], v[88:91], v[160:175]
    v_mfma_f32_32x32x16_bf16 v[176:191], v[76:79], v[92:95], v[176:191]
    s_waitcnt lgkmcnt(0)
    v_mfma_f32_32x32x16_bf16 v[128:143], v[96:99], v[112:115], v[128:143]
    v_mfma_f32_32x32x16_bf16 v[144:159], v[96:99], v[116:119], v[144:159]
    s_add_u32 m0, s45, 0
    s_add_u32 s52, s50, 28672
    buffer_load_dwordx4 v25, s[36:39], s52 offen lds
    v_mfma_f32_32x32x16_bf16 v[160:175], v[100:103], v[112:115], v[160:175]
    v_mfma_f32_32x32x16_bf16 v[176:191], v[100:103], v[116:119], v[176:191]
    s_add_u32 m0, s45, 1024
    s_add_u32 s52, s50, 28672
    buffer_load_dwordx4 v26, s[36:39], s52 offen lds
    s_waitcnt vmcnt(13)
    ds_read_b64_tr_b16 v[64:65], v16 offset:8192
    ds_read_b64_tr_b16 v[66:67], v16 offset:8704
    ds_read_b64_tr_b16 v[68:69], v17 offset:8192
    ds_read_b64_tr_b16 v[70:71], v17 offset:8704
    ds_read_b128 v[80:83], v44 offset:768
    ds_read_b128 v[84:87], v44 offset:33536
    ds_read_b64_tr_b16 v[72:73], v16 offset:10240
    ds_read_b64_tr_b16 v[74:75], v16 offset:10752
    ds_read_b64_tr_b16 v[76:77], v17 offset:10240
    ds_read_b64_tr_b16 v[78:79], v17 offset:10752
    ds_read_b128 v[88:91], v45 offset:768
    ds_read_b128 v[92:95], v45 offset:33536
    v_mfma_f32_32x32x16_bf16 v[128:143], v[104:107], v[120:123], v[128:143]
    v_mfma_f32_32x32x16_bf16 v[144:159], v[104:107], v[124:127], v[144:159]
    s_add_u32 m0, s45, 2048
    s_add_u32 s52, s50, 28672
    buffer_load_dwordx4 v27, s[36:39], s52 offen lds
    v_mfma_f32_32x32x16_bf16 v[160:175], v[108:111], v[120:123], v[160:175]
    v_mfma_f32_32x32x16_bf16 v[176:191], v[108:111], v[124:127], v[176:191]
    s_add_u32 m0, s45, 3072
    s_add_u32 s52, s50, 28672
    buffer_load_dwordx4 v28, s[36:39], s52 offen lds
    s_waitcnt lgkmcnt(0)
    v_mfma_f32_32x32x16_bf16 v[128:143], v[64:67], v[80:83], v[128:143]
    v_mfma_f32_32x32x16_bf16 v[144:159], v[64:67], v[84:87], v[144:159]
    s_add_u32 m0, s45, 4096
    s_add_u32 s52, s50, 28672
    buffer_load_dwordx4 v29, s[36:39], s52 offen lds
    v_mfma_f32_32x32x16_bf16 v[160:175], v[68:71], v[80:83], v[160:175]
    v_mfma_f32_32x32x16_bf16 v[176:191], v[68:71], v[84:87], v[176:191]
    s_add_u32 m0, s45, 5120
    s_add_u32 s52, s50, 28672
    buffer_load_dwordx4 v30, s[36:39], s52 offen lds
    s_waitcnt vmcnt(13)
    ds_read_b64_tr_b16 v[96:97], v16 offset:12288
    ds_read_b64_tr_b16 v[98:99], v16 offset:12800
    ds_read_b64_tr_b16 v[100:101], v17 offset:12288
    ds_read_b64_tr_b16 v[102:103], v17 offset:12800
    ds_read_b128 v[112:115], v46 offset:768
    ds_read_b128 v[116:119], v46 offset:33536
    ds_read_b64_tr_b16 v[104:105], v16 offset:14336
    ds_read_b64_tr_b16 v[106:107], v16 offset:14848
    ds_read_b64_tr_b16 v[108:109], v17 offset:14336
    ds_read_b64_tr_b16 v[110:111], v17 offset:14848
    ds_read_b128 v[120:123], v47 offset:768
    ds_read_b128 v[124:127], v47 offset:33536
    v_mfma_f32_32x32x16_bf16 v[128:143], v[72:75], v[88:91], v[128:143]
    v_mfma_f32_32x32x16_bf16 v[144:159], v[72:75], v[92:95], v[144:159]
    s_add_u32 m0, s45, 6144
    s_add_u32 s52, s50, 28672
    buffer_load_dwordx4 v31, s[36:39], s52 offen lds
    v_mfma_f32_32x32x16_bf16 v[160:175], v[76:79], v[88:91], v[160:175]
    v_mfma_f32_32x32x16_bf16 v[176:191], v[76:79], v[92:95], v[176:191]
    s_waitcnt lgkmcnt(0)
    v_mfma_f32_32x32x16_bf16 v[128:143], v[96:99], v[112:115], v[128:143]
    v_mfma_f32_32x32x16_bf16 v[144:159], v[96:99], v[116:119], v[144:159]
    s_add_u32 m0, s45, 7168
    s_add_u32 s52, s50, 57344
    buffer_load_dwordx4 v25, s[36:39], s52 offen lds
    v_mfma_f32_32x32x16_bf16 v[160:175], v[100:103], v[112:115], v[160:175]
    v_mfma_f32_32x32x16_bf16 v[176:191], v[100:103], v[116:119], v[176:191]
    s_add_u32 m0, s45, 8192
    s_add_u32 s52, s50, 57344
    buffer_load_dwordx4 v26, s[36:39], s52 offen lds
    v_mfma_f32_32x32x16_bf16 v[128:143], v[104:107], v[120:123], v[128:143]
    v_mfma_f32_32x32x16_bf16 v[144:159], v[104:107], v[124:127], v[144:159]
    s_add_u32 m0, s45, 9216
    s_add_u32 s52, s50, 57344
    buffer_load_dwordx4 v27, s[36:39], s52 offen lds
    v_mfma_f32_32x32x16_bf16 v[160:175], v[108:111], v[120:123], v[160:175]
    v_mfma_f32_32x32x16_bf16 v[176:191], v[108:111], v[124:127], v[176:191]
    s_add_u32 m0, s45, 10240
    s_add_u32 s52, s50, 57344
    buffer_load_dwordx4 v28, s[36:39], s52 offen lds
    s_add_u32 m0, s45, 11264
    s_add_u32 s52, s50, 57344
    buffer_load_dwordx4 v29, s[36:39], s52 offen lds
    s_add_u32 m0, s45, 12288
    s_add_u32 s52, s50, 57344
    buffer_load_dwordx4 v30, s[36:39], s52 offen lds
    s_add_u32 m0, s45, 13312
    s_add_u32 s52, s50, 57344
    buffer_load_dwordx4 v31, s[36:39], s52 offen lds
    s_barrier
    s_nop 15
    s_lshr_b32 s52, s44, 1
    s_lshl_b32 s52, s52, 8
    s_add_u32 s52, s52, 98304
    s_and_b32 s57, s44, 1
    s_lshl_b32 s57, s57, 3
    v_and_b32 v4, 15, v2
    v_xor_b32 v4, v3, v4
    v_xor_b32 v4, s57, v4
    v_lshlrev_b32 v4, 4, v4
    v_lshl_add_u32 v4, v2, 9, v4
    v_add_u32 v32, s52, v4
    v_cvt_pk_bf16_f32 v48, v128, v129
    v_cvt_pk_bf16_f32 v49, v130, v131
    v_xor_b32 v33, 0, v32
    ds_write_b64 v33, v[48:49] offset:0
    v_cvt_pk_bf16_f32 v48, v132, v133
    v_cvt_pk_bf16_f32 v49, v134, v135
    v_xor_b32 v33, 32, v32
    ds_write_b64 v33, v[48:49] offset:0
    v_cvt_pk_bf16_f32 v48, v136, v137
    v_cvt_pk_bf16_f32 v49, v138, v139
    v_xor_b32 v33, 0, v32
    ds_write_b64 v33, v[48:49] offset:8
    v_cvt_pk_bf16_f32 v48, v140, v141
    v_cvt_pk_bf16_f32 v49, v142, v143
    v_xor_b32 v33, 32, v32
    ds_write_b64 v33, v[48:49] offset:8
    v_cvt_pk_bf16_f32 v48, v144, v145
    v_cvt_pk_bf16_f32 v49, v146, v147
    v_xor_b32 v33, 0, v32
    ds_write_b64 v33, v[48:49] offset:16384
    v_cvt_pk_bf16_f32 v48, v148, v149
    v_cvt_pk_bf16_f32 v49, v150, v151
    v_xor_b32 v33, 32, v32
    ds_write_b64 v33, v[48:49] offset:16384
    v_cvt_pk_bf16_f32 v48, v152, v153
    v_cvt_pk_bf16_f32 v49, v154, v155
    v_xor_b32 v33, 0, v32
    ds_write_b64 v33, v[48:49] offset:16392
    v_cvt_pk_bf16_f32 v48, v156, v157
    v_cvt_pk_bf16_f32 v49, v158, v159
    v_xor_b32 v33, 32, v32
    ds_write_b64 v33, v[48:49] offset:16392
    v_cvt_pk_bf16_f32 v48, v160, v161
    v_cvt_pk_bf16_f32 v49, v162, v163
    v_xor_b32 v33, 64, v32
    ds_write_b64 v33, v[48:49] offset:0
    v_cvt_pk_bf16_f32 v48, v164, v165
    v_cvt_pk_bf16_f32 v49, v166, v167
    v_xor_b32 v33, 96, v32
    ds_write_b64 v33, v[48:49] offset:0
    v_cvt_pk_bf16_f32 v48, v168, v169
    v_cvt_pk_bf16_f32 v49, v170, v171
    v_xor_b32 v33, 64, v32
    ds_write_b64 v33, v[48:49] offset:8
    v_cvt_pk_bf16_f32 v48, v172, v173
    v_cvt_pk_bf16_f32 v49, v174, v175
    v_xor_b32 v33, 96, v32
    ds_write_b64 v33, v[48:49] offset:8
    v_cvt_pk_bf16_f32 v48, v176, v177
    v_cvt_pk_bf16_f32 v49, v178, v179
    v_xor_b32 v33, 64, v32
    ds_write_b64 v33, v[48:49] offset:16384
    v_cvt_pk_bf16_f32 v48, v180, v181
    v_cvt_pk_bf16_f32 v49, v182, v183
    v_xor_b32 v33, 96, v32
    ds_write_b64 v33, v[48:49] offset:16384
    v_cvt_pk_bf16_f32 v48, v184, v185
    v_cvt_pk_bf16_f32 v49, v186, v187
    v_xor_b32 v33, 64, v32
    ds_write_b64 v33, v[48:49] offset:16392
    v_cvt_pk_bf16_f32 v48, v188, v189
    v_cvt_pk_bf16_f32 v49, v190, v191
    v_xor_b32 v33, 96, v32
    ds_write_b64 v33, v[48:49] offset:16392
    s_waitcnt lgkmcnt(0)
    s_barrier
    v_and_b32 v4, 15, v1
    v_lshrrev_b32 v5, 4, v1
    v_xor_b32 v5, v5, v4
    v_lshlrev_b32 v5, 4, v5
    v_lshl_add_u32 v5, v4, 9, v5
    v_add_u32 v32, 98304, v5
    v_xor_b32 v33, 0, v32
    ds_read_b128 a[0:3], v33 offset:0
    ds_read_b128 a[4:7], v33 offset:8192
    ds_read_b128 a[8:11], v33 offset:16384
    ds_read_b128 a[12:15], v33 offset:24576
    ds_read_b128 a[64:67], v33 offset:256
    ds_read_b128 a[68:71], v33 offset:8448
    ds_read_b128 a[72:75], v33 offset:16640
    ds_read_b128 a[76:79], v33 offset:24832
    s_waitcnt lgkmcnt(0)
    v_xor_b32 v33, 64, v32
    ds_read_b128 a[16:19], v33 offset:0
    ds_read_b128 a[20:23], v33 offset:8192
    ds_read_b128 a[24:27], v33 offset:16384
    ds_read_b128 a[28:31], v33 offset:24576
    ds_read_b128 a[80:83], v33 offset:256
    ds_read_b128 a[84:87], v33 offset:8448
    ds_read_b128 a[88:91], v33 offset:16640
    ds_read_b128 a[92:95], v33 offset:24832
    s_waitcnt lgkmcnt(0)
    v_xor_b32 v33, 128, v32
    ds_read_b128 a[32:35], v33 offset:0
    ds_read_b128 a[36:39], v33 offset:8192
    ds_read_b128 a[40:43], v33 offset:16384
    ds_read_b128 a[44:47], v33 offset:24576
    ds_read_b128 a[96:99], v33 offset:256
    ds_read_b128 a[100:103], v33 offset:8448
    ds_read_b128 a[104:107], v33 offset:16640
    ds_read_b128 a[108:111], v33 offset:24832
    s_waitcnt lgkmcnt(0)
    v_xor_b32 v33, 192, v32
    ds_read_b128 a[48:51], v33 offset:0
    ds_read_b128 a[52:55], v33 offset:8192
    ds_read_b128 a[56:59], v33 offset:16384
    ds_read_b128 a[60:63], v33 offset:24576
    ds_read_b128 a[112:115], v33 offset:256
    ds_read_b128 a[116:119], v33 offset:8448
    ds_read_b128 a[120:123], v33 offset:16640
    ds_read_b128 a[124:127], v33 offset:24832
    s_waitcnt lgkmcnt(0)
    s_waitcnt vmcnt(14)
    ds_read_b64_tr_b16 v[64:65], v18 offset:16384
    ds_read_b64_tr_b16 v[66:67], v18 offset:19968
    ds_read_b64_tr_b16 v[68:69], v18 offset:16416
    ds_read_b64_tr_b16 v[70:71], v18 offset:20000
    ds_read_b64_tr_b16 v[72:73], v18 offset:16448
    ds_read_b64_tr_b16 v[74:75], v18 offset:20032
    ds_read_b64_tr_b16 v[76:77], v18 offset:16480
    ds_read_b64_tr_b16 v[78:79], v18 offset:20064
    ds_read_b64_tr_b16 v[80:81], v18 offset:16512
    ds_read_b64_tr_b16 v[82:83], v18 offset:20096
    ds_read_b64_tr_b16 v[84:85], v18 offset:16544
    ds_read_b64_tr_b16 v[86:87], v18 offset:20128
    ds_read_b64_tr_b16 v[88:89], v18 offset:16576
    ds_read_b64_tr_b16 v[90:91], v18 offset:20160
    s_waitcnt lgkmcnt(0)
    v_mfma_f32_16x16x32_bf16 v[128:131], v[64:67], a[0:3], 0
    v_mfma_f32_16x16x32_bf16 v[132:135], v[64:67], a[4:7], 0
    v_mfma_f32_16x16x32_bf16 v[136:139], v[64:67], a[8:11], 0
    v_mfma_f32_16x16x32_bf16 v[140:143], v[64:67], a[12:15], 0
    s_add_u32 m0, s45, 14336
    s_add_u32 s52, s50, 86016
    buffer_load_dwordx4 v25, s[36:39], s52 offen lds
    v_mfma_f32_16x16x32_bf16 v[144:147], v[68:71], a[0:3], 0
    v_mfma_f32_16x16x32_bf16 v[148:151], v[68:71], a[4:7], 0
    v_mfma_f32_16x16x32_bf16 v[152:155], v[68:71], a[8:11], 0
    v_mfma_f32_16x16x32_bf16 v[156:159], v[68:71], a[12:15], 0
    s_add_u32 m0, s45, 15360
    s_add_u32 s52, s50, 86016
    buffer_load_dwordx4 v26, s[36:39], s52 offen lds
    v_mfma_f32_16x16x32_bf16 v[160:163], v[72:75], a[0:3], 0
    v_mfma_f32_16x16x32_bf16 v[164:167], v[72:75], a[4:7], 0
    v_mfma_f32_16x16x32_bf16 v[168:171], v[72:75], a[8:11], 0
    v_mfma_f32_16x16x32_bf16 v[172:175], v[72:75], a[12:15], 0
    s_add_u32 m0, s45, 16384
    s_add_u32 s52, s50, 86016
    buffer_load_dwordx4 v27, s[36:39], s52 offen lds
    v_mfma_f32_16x16x32_bf16 v[176:179], v[76:79], a[0:3], 0
    v_mfma_f32_16x16x32_bf16 v[180:183], v[76:79], a[4:7], 0
    v_mfma_f32_16x16x32_bf16 v[184:187], v[76:79], a[8:11], 0
    v_mfma_f32_16x16x32_bf16 v[188:191], v[76:79], a[12:15], 0
    s_add_u32 m0, s45, 17408
    s_add_u32 s52, s50, 86016
    buffer_load_dwordx4 v28, s[36:39], s52 offen lds
    s_waitcnt vmcnt(11)
    ds_read_b64_tr_b16 v[96:97], v18 offset:0
    ds_read_b64_tr_b16 v[98:99], v18 offset:3584
    ds_read_b64_tr_b16 v[100:101], v18 offset:32
    ds_read_b64_tr_b16 v[102:103], v18 offset:3616
    ds_read_b64_tr_b16 v[104:105], v18 offset:64
    ds_read_b64_tr_b16 v[106:107], v18 offset:3648
    ds_read_b64_tr_b16 v[108:109], v18 offset:96
    ds_read_b64_tr_b16 v[110:111], v18 offset:3680
    ds_read_b64_tr_b16 v[112:113], v18 offset:128
    ds_read_b64_tr_b16 v[114:115], v18 offset:3712
    ds_read_b64_tr_b16 v[116:117], v18 offset:160
    ds_read_b64_tr_b16 v[118:119], v18 offset:3744
    ds_read_b64_tr_b16 v[120:121], v18 offset:192
    ds_read_b64_tr_b16 v[122:123], v18 offset:3776
    v_mfma_f32_16x16x32_bf16 v[192:195], v[80:83], a[0:3], 0
    v_mfma_f32_16x16x32_bf16 v[196:199], v[80:83], a[4:7], 0
    v_mfma_f32_16x16x32_bf16 v[200:203], v[80:83], a[8:11], 0
    v_mfma_f32_16x16x32_bf16 v[204:207], v[80:83], a[12:15], 0
    s_add_u32 m0, s45, 18432
    s_add_u32 s52, s50, 86016
    buffer_load_dwordx4 v29, s[36:39], s52 offen lds
    v_mfma_f32_16x16x32_bf16 v[208:211], v[84:87], a[0:3], 0
    v_mfma_f32_16x16x32_bf16 v[212:215], v[84:87], a[4:7], 0
    v_mfma_f32_16x16x32_bf16 v[216:219], v[84:87], a[8:11], 0
    v_mfma_f32_16x16x32_bf16 v[220:223], v[84:87], a[12:15], 0
    s_add_u32 m0, s45, 19456
    s_add_u32 s52, s50, 86016
    buffer_load_dwordx4 v30, s[36:39], s52 offen lds
    v_mfma_f32_16x16x32_bf16 v[224:227], v[88:91], a[0:3], 0
    v_mfma_f32_16x16x32_bf16 v[228:231], v[88:91], a[4:7], 0
    v_mfma_f32_16x16x32_bf16 v[232:235], v[88:91], a[8:11], 0
    v_mfma_f32_16x16x32_bf16 v[236:239], v[88:91], a[12:15], 0
    s_add_u32 m0, s45, 20480
    s_add_u32 s52, s50, 86016
    buffer_load_dwordx4 v31, s[36:39], s52 offen lds
    s_waitcnt lgkmcnt(0)
    v_mfma_f32_16x16x32_bf16 v[128:131], v[96:99], a[16:19], v[128:131]
    v_mfma_f32_16x16x32_bf16 v[132:135], v[96:99], a[20:23], v[132:135]
    v_mfma_f32_16x16x32_bf16 v[136:139], v[96:99], a[24:27], v[136:139]
    v_mfma_f32_16x16x32_bf16 v[140:143], v[96:99], a[28:31], v[140:143]
    s_add_u32 m0, s45, 0
    s_add_u32 s52, s50, 114688
    buffer_load_dwordx4 v25, s[36:39], s52 offen lds
    v_mfma_f32_16x16x32_bf16 v[144:147], v[100:103], a[16:19], v[144:147]
    v_mfma_f32_16x16x32_bf16 v[148:151], v[100:103], a[20:23], v[148:151]
    v_mfma_f32_16x16x32_bf16 v[152:155], v[100:103], a[24:27], v[152:155]
    v_mfma_f32_16x16x32_bf16 v[156:159], v[100:103], a[28:31], v[156:159]
    s_add_u32 m0, s45, 1024
    s_add_u32 s52, s50, 114688
    buffer_load_dwordx4 v26, s[36:39], s52 offen lds
    v_mfma_f32_16x16x32_bf16 v[160:163], v[104:107], a[16:19], v[160:163]
    v_mfma_f32_16x16x32_bf16 v[164:167], v[104:107], a[20:23], v[164:167]
    v_mfma_f32_16x16x32_bf16 v[168:171], v[104:107], a[24:27], v[168:171]
    v_mfma_f32_16x16x32_bf16 v[172:175], v[104:107], a[28:31], v[172:175]
    s_add_u32 m0, s45, 2048
    s_add_u32 s52, s50, 114688
    buffer_load_dwordx4 v27, s[36:39], s52 offen lds
    v_mfma_f32_16x16x32_bf16 v[176:179], v[108:111], a[16:19], v[176:179]
    v_mfma_f32_16x16x32_bf16 v[180:183], v[108:111], a[20:23], v[180:183]
    v_mfma_f32_16x16x32_bf16 v[184:187], v[108:111], a[24:27], v[184:187]
    v_mfma_f32_16x16x32_bf16 v[188:191], v[108:111], a[28:31], v[188:191]
    s_add_u32 m0, s45, 3072
    s_add_u32 s52, s50, 114688
    buffer_load_dwordx4 v28, s[36:39], s52 offen lds
    s_waitcnt vmcnt(11)
    ds_read_b64_tr_b16 v[64:65], v18 offset:7168
    ds_read_b64_tr_b16 v[66:67], v18 offset:10752
    ds_read_b64_tr_b16 v[68:69], v18 offset:7200
    ds_read_b64_tr_b16 v[70:71], v18 offset:10784
    ds_read_b64_tr_b16 v[72:73], v18 offset:7232
    ds_read_b64_tr_b16 v[74:75], v18 offset:10816
    ds_read_b64_tr_b16 v[76:77], v18 offset:7264
    ds_read_b64_tr_b16 v[78:79], v18 offset:10848
    ds_read_b64_tr_b16 v[80:81], v18 offset:7296
    ds_read_b64_tr_b16 v[82:83], v18 offset:10880
    ds_read_b64_tr_b16 v[84:85], v18 offset:7328
    ds_read_b64_tr_b16 v[86:87], v18 offset:10912
    ds_read_b64_tr_b16 v[88:89], v18 offset:7360
    ds_read_b64_tr_b16 v[90:91], v18 offset:10944
    v_mfma_f32_16x16x32_bf16 v[192:195], v[112:115], a[16:19], v[192:195]
    v_mfma_f32_16x16x32_bf16 v[196:199], v[112:115], a[20:23], v[196:199]
    v_mfma_f32_16x16x32_bf16 v[200:203], v[112:115], a[24:27], v[200:203]
    v_mfma_f32_16x16x32_bf16 v[204:207], v[112:115], a[28:31], v[204:207]
    s_add_u32 m0, s45, 4096
    s_add_u32 s52, s50, 114688
    buffer_load_dwordx4 v29, s[36:39], s52 offen lds
    v_mfma_f32_16x16x32_bf16 v[208:211], v[116:119], a[16:19], v[208:211]
    v_mfma_f32_16x16x32_bf16 v[212:215], v[116:119], a[20:23], v[212:215]
    v_mfma_f32_16x16x32_bf16 v[216:219], v[116:119], a[24:27], v[216:219]
    v_mfma_f32_16x16x32_bf16 v[220:223], v[116:119], a[28:31], v[220:223]
    s_add_u32 m0, s45, 5120
    s_add_u32 s52, s50, 114688
    buffer_load_dwordx4 v30, s[36:39], s52 offen lds
    v_mfma_f32_16x16x32_bf16 v[224:227], v[120:123], a[16:19], v[224:227]
    v_mfma_f32_16x16x32_bf16 v[228:231], v[120:123], a[20:23], v[228:231]
    v_mfma_f32_16x16x32_bf16 v[232:235], v[120:123], a[24:27], v[232:235]
    v_mfma_f32_16x16x32_bf16 v[236:239], v[120:123], a[28:31], v[236:239]
    s_add_u32 m0, s45, 6144
    s_add_u32 s52, s50, 114688
    buffer_load_dwordx4 v31, s[36:39], s52 offen lds
    s_waitcnt lgkmcnt(0)
    v_mfma_f32_16x16x32_bf16 v[128:131], v[64:67], a[32:35], v[128:131]
    v_mfma_f32_16x16x32_bf16 v[132:135], v[64:67], a[36:39], v[132:135]
    v_mfma_f32_16x16x32_bf16 v[136:139], v[64:67], a[40:43], v[136:139]
    v_mfma_f32_16x16x32_bf16 v[140:143], v[64:67], a[44:47], v[140:143]
    s_add_u32 m0, s45, 7168
    s_add_u32 s52, s50, 143360
    buffer_load_dwordx4 v25, s[36:39], s52 offen lds
    v_mfma_f32_16x16x32_bf16 v[144:147], v[68:71], a[32:35], v[144:147]
    v_mfma_f32_16x16x32_bf16 v[148:151], v[68:71], a[36:39], v[148:151]
    v_mfma_f32_16x16x32_bf16 v[152:155], v[68:71], a[40:43], v[152:155]
    v_mfma_f32_16x16x32_bf16 v[156:159], v[68:71], a[44:47], v[156:159]
    s_add_u32 m0, s45, 8192
    s_add_u32 s52, s50, 143360
    buffer_load_dwordx4 v26, s[36:39], s52 offen lds
    v_mfma_f32_16x16x32_bf16 v[160:163], v[72:75], a[32:35], v[160:163]
    v_mfma_f32_16x16x32_bf16 v[164:167], v[72:75], a[36:39], v[164:167]
    v_mfma_f32_16x16x32_bf16 v[168:171], v[72:75], a[40:43], v[168:171]
    v_mfma_f32_16x16x32_bf16 v[172:175], v[72:75], a[44:47], v[172:175]
    s_add_u32 m0, s45, 9216
    s_add_u32 s52, s50, 143360
    buffer_load_dwordx4 v27, s[36:39], s52 offen lds
    v_mfma_f32_16x16x32_bf16 v[176:179], v[76:79], a[32:35], v[176:179]
    v_mfma_f32_16x16x32_bf16 v[180:183], v[76:79], a[36:39], v[180:183]
    v_mfma_f32_16x16x32_bf16 v[184:187], v[76:79], a[40:43], v[184:187]
    v_mfma_f32_16x16x32_bf16 v[188:191], v[76:79], a[44:47], v[188:191]
    s_add_u32 m0, s45, 10240
    s_add_u32 s52, s50, 143360
    buffer_load_dwordx4 v28, s[36:39], s52 offen lds
    s_waitcnt vmcnt(11)
    ds_read_b64_tr_b16 v[96:97], v18 offset:14336
    ds_read_b64_tr_b16 v[98:99], v18 offset:17920
    ds_read_b64_tr_b16 v[100:101], v18 offset:14368
    ds_read_b64_tr_b16 v[102:103], v18 offset:17952
    ds_read_b64_tr_b16 v[104:105], v18 offset:14400
    ds_read_b64_tr_b16 v[106:107], v18 offset:17984
    ds_read_b64_tr_b16 v[108:109], v18 offset:14432
    ds_read_b64_tr_b16 v[110:111], v18 offset:18016
    ds_read_b64_tr_b16 v[112:113], v18 offset:14464
    ds_read_b64_tr_b16 v[114:115], v18 offset:18048
    ds_read_b64_tr_b16 v[116:117], v18 offset:14496
    ds_read_b64_tr_b16 v[118:119], v18 offset:18080
    ds_read_b64_tr_b16 v[120:121], v18 offset:14528
    ds_read_b64_tr_b16 v[122:123], v18 offset:18112
    v_mfma_f32_16x16x32_bf16 v[192:195], v[80:83], a[32:35], v[192:195]
    v_mfma_f32_16x16x32_bf16 v[196:199], v[80:83], a[36:39], v[196:199]
    v_mfma_f32_16x16x32_bf16 v[200:203], v[80:83], a[40:43], v[200:203]
    v_mfma_f32_16x16x32_bf16 v[204:207], v[80:83], a[44:47], v[204:207]
    s_add_u32 m0, s45, 11264
    s_add_u32 s52, s50, 143360
    buffer_load_dwordx4 v29, s[36:39], s52 offen lds
    v_mfma_f32_16x16x32_bf16 v[208:211], v[84:87], a[32:35], v[208:211]
    v_mfma_f32_16x16x32_bf16 v[212:215], v[84:87], a[36:39], v[212:215]
    v_mfma_f32_16x16x32_bf16 v[216:219], v[84:87], a[40:43], v[216:219]
    v_mfma_f32_16x16x32_bf16 v[220:223], v[84:87], a[44:47], v[220:223]
    s_add_u32 m0, s45, 12288
    s_add_u32 s52, s50, 143360
    buffer_load_dwordx4 v30, s[36:39], s52 offen lds
    v_mfma_f32_16x16x32_bf16 v[224:227], v[88:91], a[32:35], v[224:227]
    v_mfma_f32_16x16x32_bf16 v[228:231], v[88:91], a[36:39], v[228:231]
    v_mfma_f32_16x16x32_bf16 v[232:235], v[88:91], a[40:43], v[232:235]
    v_mfma_f32_16x16x32_bf16 v[236:239], v[88:91], a[44:47], v[236:239]
    s_add_u32 m0, s45, 13312
    s_add_u32 s52, s50, 143360
    buffer_load_dwordx4 v31, s[36:39], s52 offen lds
    s_waitcnt lgkmcnt(0)
    v_mfma_f32_16x16x32_bf16 v[128:131], v[96:99], a[48:51], v[128:131]
    v_mfma_f32_16x16x32_bf16 v[132:135], v[96:99], a[52:55], v[132:135]
    v_mfma_f32_16x16x32_bf16 v[136:139], v[96:99], a[56:59], v[136:139]
    v_mfma_f32_16x16x32_bf16 v[140:143], v[96:99], a[60:63], v[140:143]
    s_add_u32 m0, s45, 14336
    s_add_u32 s52, s50, 172032
    buffer_load_dwordx4 v25, s[36:39], s52 offen lds
    v_mfma_f32_16x16x32_bf16 v[144:147], v[100:103], a[48:51], v[144:147]
    v_mfma_f32_16x16x32_bf16 v[148:151], v[100:103], a[52:55], v[148:151]
    v_mfma_f32_16x16x32_bf16 v[152:155], v[100:103], a[56:59], v[152:155]
    v_mfma_f32_16x16x32_bf16 v[156:159], v[100:103], a[60:63], v[156:159]
    s_add_u32 m0, s45, 15360
    s_add_u32 s52, s50, 172032
    buffer_load_dwordx4 v26, s[36:39], s52 offen lds
    v_mfma_f32_16x16x32_bf16 v[160:163], v[104:107], a[48:51], v[160:163]
    v_mfma_f32_16x16x32_bf16 v[164:167], v[104:107], a[52:55], v[164:167]
    v_mfma_f32_16x16x32_bf16 v[168:171], v[104:107], a[56:59], v[168:171]
    v_mfma_f32_16x16x32_bf16 v[172:175], v[104:107], a[60:63], v[172:175]
    s_add_u32 m0, s45, 16384
    s_add_u32 s52, s50, 172032
    buffer_load_dwordx4 v27, s[36:39], s52 offen lds
    v_mfma_f32_16x16x32_bf16 v[176:179], v[108:111], a[48:51], v[176:179]
    v_mfma_f32_16x16x32_bf16 v[180:183], v[108:111], a[52:55], v[180:183]
    v_mfma_f32_16x16x32_bf16 v[184:187], v[108:111], a[56:59], v[184:187]
    v_mfma_f32_16x16x32_bf16 v[188:191], v[108:111], a[60:63], v[188:191]
    s_add_u32 m0, s45, 17408
    s_add_u32 s52, s50, 172032
    buffer_load_dwordx4 v28, s[36:39], s52 offen lds
    s_waitcnt vmcnt(11)
    ds_read_b64_tr_b16 v[64:65], v18 offset:0
    ds_read_b64_tr_b16 v[66:67], v18 offset:3584
    ds_read_b64_tr_b16 v[68:69], v18 offset:32
    ds_read_b64_tr_b16 v[70:71], v18 offset:3616
    ds_read_b64_tr_b16 v[72:73], v18 offset:64
    ds_read_b64_tr_b16 v[74:75], v18 offset:3648
    ds_read_b64_tr_b16 v[76:77], v18 offset:96
    ds_read_b64_tr_b16 v[78:79], v18 offset:3680
    ds_read_b64_tr_b16 v[80:81], v18 offset:128
    ds_read_b64_tr_b16 v[82:83], v18 offset:3712
    ds_read_b64_tr_b16 v[84:85], v18 offset:160
    ds_read_b64_tr_b16 v[86:87], v18 offset:3744
    ds_read_b64_tr_b16 v[88:89], v18 offset:192
    ds_read_b64_tr_b16 v[90:91], v18 offset:3776
    v_mfma_f32_16x16x32_bf16 v[192:195], v[112:115], a[48:51], v[192:195]
    v_mfma_f32_16x16x32_bf16 v[196:199], v[112:115], a[52:55], v[196:199]
    v_mfma_f32_16x16x32_bf16 v[200:203], v[112:115], a[56:59], v[200:203]
    v_mfma_f32_16x16x32_bf16 v[204:207], v[112:115], a[60:63], v[204:207]
    s_add_u32 m0, s45, 18432
    s_add_u32 s52, s50, 172032
    buffer_load_dwordx4 v29, s[36:39], s52 offen lds
    v_mfma_f32_16x16x32_bf16 v[208:211], v[116:119], a[48:51], v[208:211]
    v_mfma_f32_16x16x32_bf16 v[212:215], v[116:119], a[52:55], v[212:215]
    v_mfma_f32_16x16x32_bf16 v[216:219], v[116:119], a[56:59], v[216:219]
    v_mfma_f32_16x16x32_bf16 v[220:223], v[116:119], a[60:63], v[220:223]
    s_add_u32 m0, s45, 19456
    s_add_u32 s52, s50, 172032
    buffer_load_dwordx4 v30, s[36:39], s52 offen lds
    v_mfma_f32_16x16x32_bf16 v[224:227], v[120:123], a[48:51], v[224:227]
    v_mfma_f32_16x16x32_bf16 v[228:231], v[120:123], a[52:55], v[228:231]
    v_mfma_f32_16x16x32_bf16 v[232:235], v[120:123], a[56:59], v[232:235]
    v_mfma_f32_16x16x32_bf16 v[236:239], v[120:123], a[60:63], v[236:239]
    s_add_u32 m0, s45, 20480
    s_add_u32 s52, s50, 172032
    buffer_load_dwordx4 v31, s[36:39], s52 offen lds
    s_waitcnt lgkmcnt(0)
    v_mfma_f32_16x16x32_bf16 v[128:131], v[64:67], a[64:67], v[128:131]
    v_mfma_f32_16x16x32_bf16 v[132:135], v[64:67], a[68:71], v[132:135]
    v_mfma_f32_16x16x32_bf16 v[136:139], v[64:67], a[72:75], v[136:139]
    v_mfma_f32_16x16x32_bf16 v[140:143], v[64:67], a[76:79], v[140:143]
    s_add_u32 m0, s45, 0
    s_add_u32 s52, s50, 200704
    buffer_load_dwordx4 v25, s[36:39], s52 offen lds
    v_mfma_f32_16x16x32_bf16 v[144:147], v[68:71], a[64:67], v[144:147]
    v_mfma_f32_16x16x32_bf16 v[148:151], v[68:71], a[68:71], v[148:151]
    v_mfma_f32_16x16x32_bf16 v[152:155], v[68:71], a[72:75], v[152:155]
    v_mfma_f32_16x16x32_bf16 v[156:159], v[68:71], a[76:79], v[156:159]
    s_add_u32 m0, s45, 1024
    s_add_u32 s52, s50, 200704
    buffer_load_dwordx4 v26, s[36:39], s52 offen lds
    v_mfma_f32_16x16x32_bf16 v[160:163], v[72:75], a[64:67], v[160:163]
    v_mfma_f32_16x16x32_bf16 v[164:167], v[72:75], a[68:71], v[164:167]
    v_mfma_f32_16x16x32_bf16 v[168:171], v[72:75], a[72:75], v[168:171]
    v_mfma_f32_16x16x32_bf16 v[172:175], v[72:75], a[76:79], v[172:175]
    s_add_u32 m0, s45, 2048
    s_add_u32 s52, s50, 200704
    buffer_load_dwordx4 v27, s[36:39], s52 offen lds
    v_mfma_f32_16x16x32_bf16 v[176:179], v[76:79], a[64:67], v[176:179]
    v_mfma_f32_16x16x32_bf16 v[180:183], v[76:79], a[68:71], v[180:183]
    v_mfma_f32_16x16x32_bf16 v[184:187], v[76:79], a[72:75], v[184:187]
    v_mfma_f32_16x16x32_bf16 v[188:191], v[76:79], a[76:79], v[188:191]
    s_add_u32 m0, s45, 3072
    s_add_u32 s52, s50, 200704
    buffer_load_dwordx4 v28, s[36:39], s52 offen lds
    s_waitcnt vmcnt(11)
    ds_read_b64_tr_b16 v[96:97], v18 offset:7168
    ds_read_b64_tr_b16 v[98:99], v18 offset:10752
    ds_read_b64_tr_b16 v[100:101], v18 offset:7200
    ds_read_b64_tr_b16 v[102:103], v18 offset:10784
    ds_read_b64_tr_b16 v[104:105], v18 offset:7232
    ds_read_b64_tr_b16 v[106:107], v18 offset:10816
    ds_read_b64_tr_b16 v[108:109], v18 offset:7264
    ds_read_b64_tr_b16 v[110:111], v18 offset:10848
    ds_read_b64_tr_b16 v[112:113], v18 offset:7296
    ds_read_b64_tr_b16 v[114:115], v18 offset:10880
    ds_read_b64_tr_b16 v[116:117], v18 offset:7328
    ds_read_b64_tr_b16 v[118:119], v18 offset:10912
    ds_read_b64_tr_b16 v[120:121], v18 offset:7360
    ds_read_b64_tr_b16 v[122:123], v18 offset:10944
    v_mfma_f32_16x16x32_bf16 v[192:195], v[80:83], a[64:67], v[192:195]
    v_mfma_f32_16x16x32_bf16 v[196:199], v[80:83], a[68:71], v[196:199]
    v_mfma_f32_16x16x32_bf16 v[200:203], v[80:83], a[72:75], v[200:203]
    v_mfma_f32_16x16x32_bf16 v[204:207], v[80:83], a[76:79], v[204:207]
    s_add_u32 m0, s45, 4096
    s_add_u32 s52, s50, 200704
    buffer_load_dwordx4 v29, s[36:39], s52 offen lds
    v_mfma_f32_16x16x32_bf16 v[208:211], v[84:87], a[64:67], v[208:211]
    v_mfma_f32_16x16x32_bf16 v[212:215], v[84:87], a[68:71], v[212:215]
    v_mfma_f32_16x16x32_bf16 v[216:219], v[84:87], a[72:75], v[216:219]
    v_mfma_f32_16x16x32_bf16 v[220:223], v[84:87], a[76:79], v[220:223]
    s_add_u32 m0, s45, 5120
    s_add_u32 s52, s50, 200704
    buffer_load_dwordx4 v30, s[36:39], s52 offen lds
    v_mfma_f32_16x16x32_bf16 v[224:227], v[88:91], a[64:67], v[224:227]
    v_mfma_f32_16x16x32_bf16 v[228:231], v[88:91], a[68:71], v[228:231]
    v_mfma_f32_16x16x32_bf16 v[232:235], v[88:91], a[72:75], v[232:235]
    v_mfma_f32_16x16x32_bf16 v[236:239], v[88:91], a[76:79], v[236:239]
    s_add_u32 m0, s45, 6144
    s_add_u32 s52, s50, 200704
    buffer_load_dwordx4 v31, s[36:39], s52 offen lds
    s_waitcnt lgkmcnt(0)
    v_mfma_f32_16x16x32_bf16 v[128:131], v[96:99], a[80:83], v[128:131]
    v_mfma_f32_16x16x32_bf16 v[132:135], v[96:99], a[84:87], v[132:135]
    v_mfma_f32_16x16x32_bf16 v[136:139], v[96:99], a[88:91], v[136:139]
    v_mfma_f32_16x16x32_bf16 v[140:143], v[96:99], a[92:95], v[140:143]
    v_mfma_f32_16x16x32_bf16 v[144:147], v[100:103], a[80:83], v[144:147]
    v_mfma_f32_16x16x32_bf16 v[148:151], v[100:103], a[84:87], v[148:151]
    v_mfma_f32_16x16x32_bf16 v[152:155], v[100:103], a[88:91], v[152:155]
    v_mfma_f32_16x16x32_bf16 v[156:159], v[100:103], a[92:95], v[156:159]
    v_mfma_f32_16x16x32_bf16 v[160:163], v[104:107], a[80:83], v[160:163]
    v_mfma_f32_16x16x32_bf16 v[164:167], v[104:107], a[84:87], v[164:167]
    v_mfma_f32_16x16x32_bf16 v[168:171], v[104:107], a[88:91], v[168:171]
    v_mfma_f32_16x16x32_bf16 v[172:175], v[104:107], a[92:95], v[172:175]
    v_mfma_f32_16x16x32_bf16 v[176:179], v[108:111], a[80:83], v[176:179]
    v_mfma_f32_16x16x32_bf16 v[180:183], v[108:111], a[84:87], v[180:183]
    v_mfma_f32_16x16x32_bf16 v[184:187], v[108:111], a[88:91], v[184:187]
    v_mfma_f32_16x16x32_bf16 v[188:191], v[108:111], a[92:95], v[188:191]
    s_waitcnt vmcnt(7)
    ds_read_b64_tr_b16 v[64:65], v18 offset:14336
    ds_read_b64_tr_b16 v[66:67], v18 offset:17920
    ds_read_b64_tr_b16 v[68:69], v18 offset:14368
    ds_read_b64_tr_b16 v[70:71], v18 offset:17952
    ds_read_b64_tr_b16 v[72:73], v18 offset:14400
    ds_read_b64_tr_b16 v[74:75], v18 offset:17984
    ds_read_b64_tr_b16 v[76:77], v18 offset:14432
    ds_read_b64_tr_b16 v[78:79], v18 offset:18016
    ds_read_b64_tr_b16 v[80:81], v18 offset:14464
    ds_read_b64_tr_b16 v[82:83], v18 offset:18048
    ds_read_b64_tr_b16 v[84:85], v18 offset:14496
    ds_read_b64_tr_b16 v[86:87], v18 offset:18080
    ds_read_b64_tr_b16 v[88:89], v18 offset:14528
    ds_read_b64_tr_b16 v[90:91], v18 offset:18112
    v_mfma_f32_16x16x32_bf16 v[192:195], v[112:115], a[80:83], v[192:195]
    v_mfma_f32_16x16x32_bf16 v[196:199], v[112:115], a[84:87], v[196:199]
    v_mfma_f32_16x16x32_bf16 v[200:203], v[112:115], a[88:91], v[200:203]
    v_mfma_f32_16x16x32_bf16 v[204:207], v[112:115], a[92:95], v[204:207]
    v_mfma_f32_16x16x32_bf16 v[208:211], v[116:119], a[80:83], v[208:211]
    v_mfma_f32_16x16x32_bf16 v[212:215], v[116:119], a[84:87], v[212:215]
    v_mfma_f32_16x16x32_bf16 v[216:219], v[116:119], a[88:91], v[216:219]
    v_mfma_f32_16x16x32_bf16 v[220:223], v[116:119], a[92:95], v[220:223]
    v_mfma_f32_16x16x32_bf16 v[224:227], v[120:123], a[80:83], v[224:227]
    v_mfma_f32_16x16x32_bf16 v[228:231], v[120:123], a[84:87], v[228:231]
    v_mfma_f32_16x16x32_bf16 v[232:235], v[120:123], a[88:91], v[232:235]
    v_mfma_f32_16x16x32_bf16 v[236:239], v[120:123], a[92:95], v[236:239]
    s_waitcnt lgkmcnt(0)
    v_mfma_f32_16x16x32_bf16 v[128:131], v[64:67], a[96:99], v[128:131]
    v_mfma_f32_16x16x32_bf16 v[132:135], v[64:67], a[100:103], v[132:135]
    v_mfma_f32_16x16x32_bf16 v[136:139], v[64:67], a[104:107], v[136:139]
    v_mfma_f32_16x16x32_bf16 v[140:143], v[64:67], a[108:111], v[140:143]
    v_mfma_f32_16x16x32_bf16 v[144:147], v[68:71], a[96:99], v[144:147]
    v_mfma_f32_16x16x32_bf16 v[148:151], v[68:71], a[100:103], v[148:151]
    v_mfma_f32_16x16x32_bf16 v[152:155], v[68:71], a[104:107], v[152:155]
    v_mfma_f32_16x16x32_bf16 v[156:159], v[68:71], a[108:111], v[156:159]
    v_mfma_f32_16x16x32_bf16 v[160:163], v[72:75], a[96:99], v[160:163]
    v_mfma_f32_16x16x32_bf16 v[164:167], v[72:75], a[100:103], v[164:167]
    v_mfma_f32_16x16x32_bf16 v[168:171], v[72:75], a[104:107], v[168:171]
    v_mfma_f32_16x16x32_bf16 v[172:175], v[72:75], a[108:111], v[172:175]
    v_mfma_f32_16x16x32_bf16 v[176:179], v[76:79], a[96:99], v[176:179]
    v_mfma_f32_16x16x32_bf16 v[180:183], v[76:79], a[100:103], v[180:183]
    v_mfma_f32_16x16x32_bf16 v[184:187], v[76:79], a[104:107], v[184:187]
    v_mfma_f32_16x16x32_bf16 v[188:191], v[76:79], a[108:111], v[188:191]
    s_waitcnt vmcnt(0)
    ds_read_b64_tr_b16 v[96:97], v18 offset:0
    ds_read_b64_tr_b16 v[98:99], v18 offset:3584
    ds_read_b64_tr_b16 v[100:101], v18 offset:32
    ds_read_b64_tr_b16 v[102:103], v18 offset:3616
    ds_read_b64_tr_b16 v[104:105], v18 offset:64
    ds_read_b64_tr_b16 v[106:107], v18 offset:3648
    ds_read_b64_tr_b16 v[108:109], v18 offset:96
    ds_read_b64_tr_b16 v[110:111], v18 offset:3680
    ds_read_b64_tr_b16 v[112:113], v18 offset:128
    ds_read_b64_tr_b16 v[114:115], v18 offset:3712
    ds_read_b64_tr_b16 v[116:117], v18 offset:160
    ds_read_b64_tr_b16 v[118:119], v18 offset:3744
    ds_read_b64_tr_b16 v[120:121], v18 offset:192
    ds_read_b64_tr_b16 v[122:123], v18 offset:3776
    v_mfma_f32_16x16x32_bf16 v[192:195], v[80:83], a[96:99], v[192:195]
    v_mfma_f32_16x16x32_bf16 v[196:199], v[80:83], a[100:103], v[196:199]
    v_mfma_f32_16x16x32_bf16 v[200:203], v[80:83], a[104:107], v[200:203]
    v_mfma_f32_16x16x32_bf16 v[204:207], v[80:83], a[108:111], v[204:207]
    v_mfma_f32_16x16x32_bf16 v[208:211], v[84:87], a[96:99], v[208:211]
    v_mfma_f32_16x16x32_bf16 v[212:215], v[84:87], a[100:103], v[212:215]
    v_mfma_f32_16x16x32_bf16 v[216:219], v[84:87], a[104:107], v[216:219]
    v_mfma_f32_16x16x32_bf16 v[220:223], v[84:87], a[108:111], v[220:223]
    v_mfma_f32_16x16x32_bf16 v[224:227], v[88:91], a[96:99], v[224:227]
    v_mfma_f32_16x16x32_bf16 v[228:231], v[88:91], a[100:103], v[228:231]
    v_mfma_f32_16x16x32_bf16 v[232:235], v[88:91], a[104:107], v[232:235]
    v_mfma_f32_16x16x32_bf16 v[236:239], v[88:91], a[108:111], v[236:239]
    s_waitcnt lgkmcnt(0)
    v_mfma_f32_16x16x32_bf16 v[128:131], v[96:99], a[112:115], v[128:131]
    v_mfma_f32_16x16x32_bf16 v[132:135], v[96:99], a[116:119], v[132:135]
    v_mfma_f32_16x16x32_bf16 v[136:139], v[96:99], a[120:123], v[136:139]
    v_mfma_f32_16x16x32_bf16 v[140:143], v[96:99], a[124:127], v[140:143]
    v_mfma_f32_16x16x32_bf16 v[144:147], v[100:103], a[112:115], v[144:147]
    v_mfma_f32_16x16x32_bf16 v[148:151], v[100:103], a[116:119], v[148:151]
    v_mfma_f32_16x16x32_bf16 v[152:155], v[100:103], a[120:123], v[152:155]
    v_mfma_f32_16x16x32_bf16 v[156:159], v[100:103], a[124:127], v[156:159]
    v_mfma_f32_16x16x32_bf16 v[160:163], v[104:107], a[112:115], v[160:163]
    v_mfma_f32_16x16x32_bf16 v[164:167], v[104:107], a[116:119], v[164:167]
    v_mfma_f32_16x16x32_bf16 v[168:171], v[104:107], a[120:123], v[168:171]
    v_mfma_f32_16x16x32_bf16 v[172:175], v[104:107], a[124:127], v[172:175]
    v_mfma_f32_16x16x32_bf16 v[176:179], v[108:111], a[112:115], v[176:179]
    v_mfma_f32_16x16x32_bf16 v[180:183], v[108:111], a[116:119], v[180:183]
    v_mfma_f32_16x16x32_bf16 v[184:187], v[108:111], a[120:123], v[184:187]
    v_mfma_f32_16x16x32_bf16 v[188:191], v[108:111], a[124:127], v[188:191]
    v_mfma_f32_16x16x32_bf16 v[192:195], v[112:115], a[112:115], v[192:195]
    v_mfma_f32_16x16x32_bf16 v[196:199], v[112:115], a[116:119], v[196:199]
    v_mfma_f32_16x16x32_bf16 v[200:203], v[112:115], a[120:123], v[200:203]
    v_mfma_f32_16x16x32_bf16 v[204:207], v[112:115], a[124:127], v[204:207]
    v_mfma_f32_16x16x32_bf16 v[208:211], v[116:119], a[112:115], v[208:211]
    v_mfma_f32_16x16x32_bf16 v[212:215], v[116:119], a[116:119], v[212:215]
    v_mfma_f32_16x16x32_bf16 v[216:219], v[116:119], a[120:123], v[216:219]
    v_mfma_f32_16x16x32_bf16 v[220:223], v[116:119], a[124:127], v[220:223]
    v_mfma_f32_16x16x32_bf16 v[224:227], v[120:123], a[112:115], v[224:227]
    v_mfma_f32_16x16x32_bf16 v[228:231], v[120:123], a[116:119], v[228:231]
    v_mfma_f32_16x16x32_bf16 v[232:235], v[120:123], a[120:123], v[232:235]
    v_mfma_f32_16x16x32_bf16 v[236:239], v[120:123], a[124:127], v[236:239]
    s_nop 15
    v_lshlrev_b32 v32, 4, v1
    v_max_f32 v40, |v128|, |v129|
    v_max_f32 v41, |v130|, |v131|
    v_max3_f32 v40, |v132|, |v133|, v40
    v_max3_f32 v41, |v134|, |v135|, v41
    v_max3_f32 v40, |v136|, |v137|, v40
    v_max3_f32 v41, |v138|, |v139|, v41
    v_max3_f32 v40, |v140|, |v141|, v40
    v_max3_f32 v41, |v142|, |v143|, v41
    v_max3_f32 v40, |v144|, |v145|, v40
    v_max3_f32 v41, |v146|, |v147|, v41
    v_max3_f32 v40, |v148|, |v149|, v40
    v_max3_f32 v41, |v150|, |v151|, v41
    v_max3_f32 v40, |v152|, |v153|, v40
    v_max3_f32 v41, |v154|, |v155|, v41
    v_max3_f32 v40, |v156|, |v157|, v40
    v_max3_f32 v41, |v158|, |v159|, v41
    v_max3_f32 v40, |v160|, |v161|, v40
    v_max3_f32 v41, |v162|, |v163|, v41
    v_max3_f32 v40, |v164|, |v165|, v40
    v_max3_f32 v41, |v166|, |v167|, v41
    v_max3_f32 v40, |v168|, |v169|, v40
    v_max3_f32 v41, |v170|, |v171|, v41
    v_max3_f32 v40, |v172|, |v173|, v40
    v_max3_f32 v41, |v174|, |v175|, v41
    v_max3_f32 v40, |v176|, |v177|, v40
    v_max3_f32 v41, |v178|, |v179|, v41
    v_max3_f32 v40, |v180|, |v181|, v40
    v_max3_f32 v41, |v182|, |v183|, v41
    v_max3_f32 v40, |v184|, |v185|, v40
    v_max3_f32 v41, |v186|, |v187|, v41
    v_max3_f32 v40, |v188|, |v189|, v40
    v_max3_f32 v41, |v190|, |v191|, v41
    v_max3_f32 v40, |v192|, |v193|, v40
    v_max3_f32 v41, |v194|, |v195|, v41
    v_max3_f32 v40, |v196|, |v197|, v40
    v_max3_f32 v41, |v198|, |v199|, v41
    v_max3_f32 v40, |v200|, |v201|, v40
    v_max3_f32 v41, |v202|, |v203|, v41
    v_max3_f32 v40, |v204|, |v205|, v40
    v_max3_f32 v41, |v206|, |v207|, v41
    v_max3_f32 v40, |v208|, |v209|, v40
    v_max3_f32 v41, |v210|, |v211|, v41
    v_max3_f32 v40, |v212|, |v213|, v40
    v_max3_f32 v41, |v214|, |v215|, v41
    v_max3_f32 v40, |v216|, |v217|, v40
    v_max3_f32 v41, |v218|, |v219|, v41
    v_max3_f32 v40, |v220|, |v221|, v40
    v_max3_f32 v41, |v222|, |v223|, v41
    v_max3_f32 v40, |v224|, |v225|, v40
    v_max3_f32 v41, |v226|, |v227|, v41
    v_max3_f32 v40, |v228|, |v229|, v40
    v_max3_f32 v41, |v230|, |v231|, v41
    v_max3_f32 v40, |v232|, |v233|, v40
    v_max3_f32 v41, |v234|, |v235|, v41
    v_max3_f32 v40, |v236|, |v237|, v40
    v_max3_f32 v41, |v238|, |v239|, v41
    v_max_f32 v40, v40, v41
    v_bfe_u32 v40, v40, 23, 8
    v_max_u32 v40, 15, v40
    v_min_u32 v40, 0xfe, v40
    v_sub_u32 v42, 0x10c, v40
    v_lshlrev_b32 v42, 23, v42
    v_subrev_u32 v43, 14, v40
    v_lshlrev_b32 v43, 23, v43
    v_lshlrev_b32 v33, 2, v1
    s_add_u32 s52, s51, 14336
    buffer_store_dword v43, v33, s[40:43], s52 offen sc1
    v_mul_f32 v128, v128, v42
    v_mul_f32 v129, v129, v42
    v_mul_f32 v130, v130, v42
    v_mul_f32 v131, v131, v42
    v_mul_f32 v132, v132, v42
    v_mul_f32 v133, v133, v42
    v_mul_f32 v134, v134, v42
    v_mul_f32 v135, v135, v42
    v_cvt_pk_f16_f32 v128, v128, v129
    v_cvt_pk_f16_f32 v129, v130, v131
    v_cvt_pk_f16_f32 v130, v132, v133
    v_cvt_pk_f16_f32 v131, v134, v135
    s_add_u32 s52, s51, 0
    buffer_store_dwordx4 v[128:131], v32, s[40:43], s52 offen offset:0 sc1
    v_mul_f32 v136, v136, v42
    v_mul_f32 v137, v137, v42
    v_mul_f32 v138, v138, v42
    v_mul_f32 v139, v139, v42
    v_mul_f32 v140, v140, v42
    v_mul_f32 v141, v141, v42
    v_mul_f32 v142, v142, v42
    v_mul_f32 v143, v143, v42
    v_cvt_pk_f16_f32 v136, v136, v137
    v_cvt_pk_f16_f32 v137, v138, v139
    v_cvt_pk_f16_f32 v138, v140, v141
    v_cvt_pk_f16_f32 v139, v142, v143
    buffer_store_dwordx4 v[136:139], v32, s[40:43], s52 offen offset:1024 sc1
    v_mul_f32 v144, v144, v42
    v_mul_f32 v145, v145, v42
    v_mul_f32 v146, v146, v42
    v_mul_f32 v147, v147, v42
    v_mul_f32 v148, v148, v42
    v_mul_f32 v149, v149, v42
    v_mul_f32 v150, v150, v42
    v_mul_f32 v151, v151, v42
    v_cvt_pk_f16_f32 v144, v144, v145
    v_cvt_pk_f16_f32 v145, v146, v147
    v_cvt_pk_f16_f32 v146, v148, v149
    v_cvt_pk_f16_f32 v147, v150, v151
    buffer_store_dwordx4 v[144:147], v32, s[40:43], s52 offen offset:2048 sc1
    v_mul_f32 v152, v152, v42
    v_mul_f32 v153, v153, v42
    v_mul_f32 v154, v154, v42
    v_mul_f32 v155, v155, v42
    v_mul_f32 v156, v156, v42
    v_mul_f32 v157, v157, v42
    v_mul_f32 v158, v158, v42
    v_mul_f32 v159, v159, v42
    v_cvt_pk_f16_f32 v152, v152, v153
    v_cvt_pk_f16_f32 v153, v154, v155
    v_cvt_pk_f16_f32 v154, v156, v157
    v_cvt_pk_f16_f32 v155, v158, v159
    buffer_store_dwordx4 v[152:155], v32, s[40:43], s52 offen offset:3072 sc1
    v_mul_f32 v160, v160, v42
    v_mul_f32 v161, v161, v42
    v_mul_f32 v162, v162, v42
    v_mul_f32 v163, v163, v42
    v_mul_f32 v164, v164, v42
    v_mul_f32 v165, v165, v42
    v_mul_f32 v166, v166, v42
    v_mul_f32 v167, v167, v42
    v_cvt_pk_f16_f32 v160, v160, v161
    v_cvt_pk_f16_f32 v161, v162, v163
    v_cvt_pk_f16_f32 v162, v164, v165
    v_cvt_pk_f16_f32 v163, v166, v167
    s_add_u32 s52, s51, 4096
    buffer_store_dwordx4 v[160:163], v32, s[40:43], s52 offen offset:0 sc1
    v_mul_f32 v168, v168, v42
    v_mul_f32 v169, v169, v42
    v_mul_f32 v170, v170, v42
    v_mul_f32 v171, v171, v42
    v_mul_f32 v172, v172, v42
    v_mul_f32 v173, v173, v42
    v_mul_f32 v174, v174, v42
    v_mul_f32 v175, v175, v42
    v_cvt_pk_f16_f32 v168, v168, v169
    v_cvt_pk_f16_f32 v169, v170, v171
    v_cvt_pk_f16_f32 v170, v172, v173
    v_cvt_pk_f16_f32 v171, v174, v175
    buffer_store_dwordx4 v[168:171], v32, s[40:43], s52 offen offset:1024 sc1
    v_mul_f32 v176, v176, v42
    v_mul_f32 v177, v177, v42
    v_mul_f32 v178, v178, v42
    v_mul_f32 v179, v179, v42
    v_mul_f32 v180, v180, v42
    v_mul_f32 v181, v181, v42
    v_mul_f32 v182, v182, v42
    v_mul_f32 v183, v183, v42
    v_cvt_pk_f16_f32 v176, v176, v177
    v_cvt_pk_f16_f32 v177, v178, v179
    v_cvt_pk_f16_f32 v178, v180, v181
    v_cvt_pk_f16_f32 v179, v182, v183
    buffer_store_dwordx4 v[176:179], v32, s[40:43], s52 offen offset:2048 sc1
    v_mul_f32 v184, v184, v42
    v_mul_f32 v185, v185, v42
    v_mul_f32 v186, v186, v42
    v_mul_f32 v187, v187, v42
    v_mul_f32 v188, v188, v42
    v_mul_f32 v189, v189, v42
    v_mul_f32 v190, v190, v42
    v_mul_f32 v191, v191, v42
    v_cvt_pk_f16_f32 v184, v184, v185
    v_cvt_pk_f16_f32 v185, v186, v187
    v_cvt_pk_f16_f32 v186, v188, v189
    v_cvt_pk_f16_f32 v187, v190, v191
    buffer_store_dwordx4 v[184:187], v32, s[40:43], s52 offen offset:3072 sc1
    v_mul_f32 v192, v192, v42
    v_mul_f32 v193, v193, v42
    v_mul_f32 v194, v194, v42
    v_mul_f32 v195, v195, v42
    v_mul_f32 v196, v196, v42
    v_mul_f32 v197, v197, v42
    v_mul_f32 v198, v198, v42
    v_mul_f32 v199, v199, v42
    v_cvt_pk_f16_f32 v192, v192, v193
    v_cvt_pk_f16_f32 v193, v194, v195
    v_cvt_pk_f16_f32 v194, v196, v197
    v_cvt_pk_f16_f32 v195, v198, v199
    s_add_u32 s52, s51, 8192
    buffer_store_dwordx4 v[192:195], v32, s[40:43], s52 offen offset:0 sc1
    v_mul_f32 v200, v200, v42
    v_mul_f32 v201, v201, v42
    v_mul_f32 v202, v202, v42
    v_mul_f32 v203, v203, v42
    v_mul_f32 v204, v204, v42
    v_mul_f32 v205, v205, v42
    v_mul_f32 v206, v206, v42
    v_mul_f32 v207, v207, v42
    v_cvt_pk_f16_f32 v200, v200, v201
    v_cvt_pk_f16_f32 v201, v202, v203
    v_cvt_pk_f16_f32 v202, v204, v205
    v_cvt_pk_f16_f32 v203, v206, v207
    buffer_store_dwordx4 v[200:203], v32, s[40:43], s52 offen offset:1024 sc1
    v_mul_f32 v208, v208, v42
    v_mul_f32 v209, v209, v42
    v_mul_f32 v210, v210, v42
    v_mul_f32 v211, v211, v42
    v_mul_f32 v212, v212, v42
    v_mul_f32 v213, v213, v42
    v_mul_f32 v214, v214, v42
    v_mul_f32 v215, v215, v42
    v_cvt_pk_f16_f32 v208, v208, v209
    v_cvt_pk_f16_f32 v209, v210, v211
    v_cvt_pk_f16_f32 v210, v212, v213
    v_cvt_pk_f16_f32 v211, v214, v215
    buffer_store_dwordx4 v[208:211], v32, s[40:43], s52 offen offset:2048 sc1
    v_mul_f32 v216, v216, v42
    v_mul_f32 v217, v217, v42
    v_mul_f32 v218, v218, v42
    v_mul_f32 v219, v219, v42
    v_mul_f32 v220, v220, v42
    v_mul_f32 v221, v221, v42
    v_mul_f32 v222, v222, v42
    v_mul_f32 v223, v223, v42
    v_cvt_pk_f16_f32 v216, v216, v217
    v_cvt_pk_f16_f32 v217, v218, v219
    v_cvt_pk_f16_f32 v218, v220, v221
    v_cvt_pk_f16_f32 v219, v222, v223
    buffer_store_dwordx4 v[216:219], v32, s[40:43], s52 offen offset:3072 sc1
    v_mul_f32 v224, v224, v42
    v_mul_f32 v225, v225, v42
    v_mul_f32 v226, v226, v42
    v_mul_f32 v227, v227, v42
    v_mul_f32 v228, v228, v42
    v_mul_f32 v229, v229, v42
    v_mul_f32 v230, v230, v42
    v_mul_f32 v231, v231, v42
    v_cvt_pk_f16_f32 v224, v224, v225
    v_cvt_pk_f16_f32 v225, v226, v227
    v_cvt_pk_f16_f32 v226, v228, v229
    v_cvt_pk_f16_f32 v227, v230, v231
    s_add_u32 s52, s51, 12288
    buffer_store_dwordx4 v[224:227], v32, s[40:43], s52 offen offset:0 sc1
    v_mul_f32 v232, v232, v42
    v_mul_f32 v233, v233, v42
    v_mul_f32 v234, v234, v42
    v_mul_f32 v235, v235, v42
    v_mul_f32 v236, v236, v42
    v_mul_f32 v237, v237, v42
    v_mul_f32 v238, v238, v42
    v_mul_f32 v239, v239, v42
    v_cvt_pk_f16_f32 v232, v232, v233
    v_cvt_pk_f16_f32 v233, v234, v235
    v_cvt_pk_f16_f32 v234, v236, v237
    v_cvt_pk_f16_f32 v235, v238, v239
    buffer_store_dwordx4 v[232:235], v32, s[40:43], s52 offen offset:1024 sc1
    s_waitcnt vmcnt(0)
L_main_end:
    s_endpgm
.p2align 8
.globl reduce_kernel
.type reduce_kernel,@function
reduce_kernel:
    s_cmp_ge_u32 s2, 224
    s_cbranch_scc1 L_red_end
    s_load_dwordx2 s[4:5], s[0:1], 40
    s_load_dwordx2 s[6:7], s[0:1], 56
    v_lshrrev_b32 v1, 6, v0
    v_and_b32 v2, 63, v0
    s_and_b32 s20, s2, 7
    v_readfirstlane_b32 s21, v1
    s_lshr_b32 s22, s2, 3
    s_cmp_ge_u32 s22, 14
    s_cselect_b32 s23, 1, 0
    s_mul_i32 s24, s23, 14
    s_sub_u32 s24, s22, s24
    s_waitcnt lgkmcnt(0)
    s_mov_b32 s8, s4
    s_and_b32 s9, s5, 0xffff
    s_mov_b32 s10, 917504
    s_mov_b32 s11, 0x00020000
    s_mov_b32 s12, s6
    s_and_b32 s13, s7, 0xffff
    s_mov_b32 s14, 15728640
    s_mov_b32 s15, 0x00020000
    s_lshl_b32 s25, s20, 1
    s_add_u32 s25, s25, s23
    s_lshl_b32 s25, s25, 6
    s_add_u32 s25, s25, s21
    s_mul_i32 s25, s25, 15
    s_add_u32 s32, s25, 14
    s_lshl_b32 s32, s32, 10
    s_add_u32 s25, s25, s24
    s_lshl_b32 s25, s25, 10
    v_lshlrev_b32 v6, 2, v2
    v_lshlrev_b32 v3, 4, v2
    s_mov_b32 s31, 0xffff0000
    s_nop 4
    s_add_u32 s26, s25, 0
    buffer_load_dwordx4 v[8:11], v3, s[12:15], s26 offen
    s_add_u32 s26, s32, 0
    buffer_load_dword v80, v6, s[12:15], s26 offen
    s_add_u32 s26, s25, 61440
    buffer_load_dwordx4 v[12:15], v3, s[12:15], s26 offen
    s_add_u32 s26, s32, 61440
    buffer_load_dword v81, v6, s[12:15], s26 offen
    s_add_u32 s26, s25, 122880
    buffer_load_dwordx4 v[16:19], v3, s[12:15], s26 offen
    s_add_u32 s26, s32, 122880
    buffer_load_dword v82, v6, s[12:15], s26 offen
    s_add_u32 s26, s25, 184320
    buffer_load_dwordx4 v[20:23], v3, s[12:15], s26 offen
    s_add_u32 s26, s32, 184320
    buffer_load_dword v83, v6, s[12:15], s26 offen
    s_add_u32 s26, s25, 245760
    buffer_load_dwordx4 v[24:27], v3, s[12:15], s26 offen
    s_add_u32 s26, s32, 245760
    buffer_load_dword v84, v6, s[12:15], s26 offen
    s_add_u32 s26, s25, 307200
    buffer_load_dwordx4 v[28:31], v3, s[12:15], s26 offen
    s_add_u32 s26, s32, 307200
    buffer_load_dword v85, v6, s[12:15], s26 offen
    s_add_u32 s26, s25, 368640
    buffer_load_dwordx4 v[32:35], v3, s[12:15], s26 offen
    s_add_u32 s26, s32, 368640
    buffer_load_dword v86, v6, s[12:15], s26 offen
    s_add_u32 s26, s25, 430080
    buffer_load_dwordx4 v[36:39], v3, s[12:15], s26 offen
    s_add_u32 s26, s32, 430080
    buffer_load_dword v87, v6, s[12:15], s26 offen
    s_add_u32 s26, s25, 491520
    buffer_load_dwordx4 v[40:43], v3, s[12:15], s26 offen
    s_add_u32 s26, s32, 491520
    buffer_load_dword v88, v6, s[12:15], s26 offen
    s_add_u32 s26, s25, 552960
    buffer_load_dwordx4 v[44:47], v3, s[12:15], s26 offen
    s_add_u32 s26, s32, 552960
    buffer_load_dword v89, v6, s[12:15], s26 offen
    s_add_u32 s26, s25, 614400
    buffer_load_dwordx4 v[48:51], v3, s[12:15], s26 offen
    s_add_u32 s26, s32, 614400
    buffer_load_dword v90, v6, s[12:15], s26 offen
    s_add_u32 s26, s25, 675840
    buffer_load_dwordx4 v[52:55], v3, s[12:15], s26 offen
    s_add_u32 s26, s32, 675840
    buffer_load_dword v91, v6, s[12:15], s26 offen
    s_add_u32 s26, s25, 737280
    buffer_load_dwordx4 v[56:59], v3, s[12:15], s26 offen
    s_add_u32 s26, s32, 737280
    buffer_load_dword v92, v6, s[12:15], s26 offen
    s_add_u32 s26, s25, 798720
    buffer_load_dwordx4 v[60:63], v3, s[12:15], s26 offen
    s_add_u32 s26, s32, 798720
    buffer_load_dword v93, v6, s[12:15], s26 offen
    s_add_u32 s26, s25, 860160
    buffer_load_dwordx4 v[64:67], v3, s[12:15], s26 offen
    s_add_u32 s26, s32, 860160
    buffer_load_dword v94, v6, s[12:15], s26 offen
    s_add_u32 s26, s25, 921600
    buffer_load_dwordx4 v[68:71], v3, s[12:15], s26 offen
    s_add_u32 s26, s32, 921600
    buffer_load_dword v95, v6, s[12:15], s26 offen
    s_and_b32 s27, s24, 1
    s_lshl_b32 s27, s27, 1
    s_lshr_b32 s28, s24, 1
    s_lshl_b32 s29, s20, 7
    s_lshl_b32 s30, s23, 6
    s_add_u32 s29, s29, s30
    s_lshl_b32 s30, s27, 4
    s_add_u32 s29, s29, s30
    s_mul_i32 s29, s29, 896
    s_mul_i32 s30, s21, 224
    s_add_u32 s29, s29, s30
    s_lshl_b32 s30, s28, 5
    s_add_u32 s29, s29, s30
    v_and_b32 v4, 15, v2
    v_mul_u32_u24 v4, 896, v4
    v_lshrrev_b32 v5, 4, v2
    v_lshl_add_u32 v4, v5, 3, v4
    v_mov_b32 v72, 0
    v_mov_b32 v73, 0
    v_mov_b32 v74, 0
    v_mov_b32 v75, 0
    v_mov_b32 v76, 0
    v_mov_b32 v77, 0
    v_mov_b32 v78, 0
    v_mov_b32 v79, 0
    s_waitcnt vmcnt(30)
    v_fma_mix_f32 v72, v8, v80, v72 op_sel_hi:[1,0,0]
    v_fma_mix_f32 v73, v8, v80, v73 op_sel:[1,0,0] op_sel_hi:[1,0,0]
    v_fma_mix_f32 v74, v9, v80, v74 op_sel_hi:[1,0,0]
    v_fma_mix_f32 v75, v9, v80, v75 op_sel:[1,0,0] op_sel_hi:[1,0,0]
    v_fma_mix_f32 v76, v10, v80, v76 op_sel_hi:[1,0,0]
    v_fma_mix_f32 v77, v10, v80, v77 op_sel:[1,0,0] op_sel_hi:[1,0,0]
    v_fma_mix_f32 v78, v11, v80, v78 op_sel_hi:[1,0,0]
    v_fma_mix_f32 v79, v11, v80, v79 op_sel:[1,0,0] op_sel_hi:[1,0,0]
    s_waitcnt vmcnt(28)
    v_fma_mix_f32 v72, v12, v81, v72 op_sel_hi:[1,0,0]
    v_fma_mix_f32 v73, v12, v81, v73 op_sel:[1,0,0] op_sel_hi:[1,0,0]
    v_fma_mix_f32 v74, v13, v81, v74 op_sel_hi:[1,0,0]
    v_fma_mix_f32 v75, v13, v81, v75 op_sel:[1,0,0] op_sel_hi:[1,0,0]
    v_fma_mix_f32 v76, v14, v81, v76 op_sel_hi:[1,0,0]
    v_fma_mix_f32 v77, v14, v81, v77 op_sel:[1,0,0] op_sel_hi:[1,0,0]
    v_fma_mix_f32 v78, v15, v81, v78 op_sel_hi:[1,0,0]
    v_fma_mix_f32 v79, v15, v81, v79 op_sel:[1,0,0] op_sel_hi:[1,0,0]
    s_waitcnt vmcnt(26)
    v_fma_mix_f32 v72, v16, v82, v72 op_sel_hi:[1,0,0]
    v_fma_mix_f32 v73, v16, v82, v73 op_sel:[1,0,0] op_sel_hi:[1,0,0]
    v_fma_mix_f32 v74, v17, v82, v74 op_sel_hi:[1,0,0]
    v_fma_mix_f32 v75, v17, v82, v75 op_sel:[1,0,0] op_sel_hi:[1,0,0]
    v_fma_mix_f32 v76, v18, v82, v76 op_sel_hi:[1,0,0]
    v_fma_mix_f32 v77, v18, v82, v77 op_sel:[1,0,0] op_sel_hi:[1,0,0]
    v_fma_mix_f32 v78, v19, v82, v78 op_sel_hi:[1,0,0]
    v_fma_mix_f32 v79, v19, v82, v79 op_sel:[1,0,0] op_sel_hi:[1,0,0]
    s_waitcnt vmcnt(24)
    v_fma_mix_f32 v72, v20, v83, v72 op_sel_hi:[1,0,0]
    v_fma_mix_f32 v73, v20, v83, v73 op_sel:[1,0,0] op_sel_hi:[1,0,0]
    v_fma_mix_f32 v74, v21, v83, v74 op_sel_hi:[1,0,0]
    v_fma_mix_f32 v75, v21, v83, v75 op_sel:[1,0,0] op_sel_hi:[1,0,0]
    v_fma_mix_f32 v76, v22, v83, v76 op_sel_hi:[1,0,0]
    v_fma_mix_f32 v77, v22, v83, v77 op_sel:[1,0,0] op_sel_hi:[1,0,0]
    v_fma_mix_f32 v78, v23, v83, v78 op_sel_hi:[1,0,0]
    v_fma_mix_f32 v79, v23, v83, v79 op_sel:[1,0,0] op_sel_hi:[1,0,0]
    s_waitcnt vmcnt(22)
    v_fma_mix_f32 v72, v24, v84, v72 op_sel_hi:[1,0,0]
    v_fma_mix_f32 v73, v24, v84, v73 op_sel:[1,0,0] op_sel_hi:[1,0,0]
    v_fma_mix_f32 v74, v25, v84, v74 op_sel_hi:[1,0,0]
    v_fma_mix_f32 v75, v25, v84, v75 op_sel:[1,0,0] op_sel_hi:[1,0,0]
    v_fma_mix_f32 v76, v26, v84, v76 op_sel_hi:[1,0,0]
    v_fma_mix_f32 v77, v26, v84, v77 op_sel:[1,0,0] op_sel_hi:[1,0,0]
    v_fma_mix_f32 v78, v27, v84, v78 op_sel_hi:[1,0,0]
    v_fma_mix_f32 v79, v27, v84, v79 op_sel:[1,0,0] op_sel_hi:[1,0,0]
    s_waitcnt vmcnt(20)
    v_fma_mix_f32 v72, v28, v85, v72 op_sel_hi:[1,0,0]
    v_fma_mix_f32 v73, v28, v85, v73 op_sel:[1,0,0] op_sel_hi:[1,0,0]
    v_fma_mix_f32 v74, v29, v85, v74 op_sel_hi:[1,0,0]
    v_fma_mix_f32 v75, v29, v85, v75 op_sel:[1,0,0] op_sel_hi:[1,0,0]
    v_fma_mix_f32 v76, v30, v85, v76 op_sel_hi:[1,0,0]
    v_fma_mix_f32 v77, v30, v85, v77 op_sel:[1,0,0] op_sel_hi:[1,0,0]
    v_fma_mix_f32 v78, v31, v85, v78 op_sel_hi:[1,0,0]
    v_fma_mix_f32 v79, v31, v85, v79 op_sel:[1,0,0] op_sel_hi:[1,0,0]
    s_waitcnt vmcnt(18)
    v_fma_mix_f32 v72, v32, v86, v72 op_sel_hi:[1,0,0]
    v_fma_mix_f32 v73, v32, v86, v73 op_sel:[1,0,0] op_sel_hi:[1,0,0]
    v_fma_mix_f32 v74, v33, v86, v74 op_sel_hi:[1,0,0]
    v_fma_mix_f32 v75, v33, v86, v75 op_sel:[1,0,0] op_sel_hi:[1,0,0]
    v_fma_mix_f32 v76, v34, v86, v76 op_sel_hi:[1,0,0]
    v_fma_mix_f32 v77, v34, v86, v77 op_sel:[1,0,0] op_sel_hi:[1,0,0]
    v_fma_mix_f32 v78, v35, v86, v78 op_sel_hi:[1,0,0]
    v_fma_mix_f32 v79, v35, v86, v79 op_sel:[1,0,0] op_sel_hi:[1,0,0]
    s_waitcnt vmcnt(16)
    v_fma_mix_f32 v72, v36, v87, v72 op_sel_hi:[1,0,0]
    v_fma_mix_f32 v73, v36, v87, v73 op_sel:[1,0,0] op_sel_hi:[1,0,0]
    v_fma_mix_f32 v74, v37, v87, v74 op_sel_hi:[1,0,0]
    v_fma_mix_f32 v75, v37, v87, v75 op_sel:[1,0,0] op_sel_hi:[1,0,0]
    v_fma_mix_f32 v76, v38, v87, v76 op_sel_hi:[1,0,0]
    v_fma_mix_f32 v77, v38, v87, v77 op_sel:[1,0,0] op_sel_hi:[1,0,0]
    v_fma_mix_f32 v78, v39, v87, v78 op_sel_hi:[1,0,0]
    v_fma_mix_f32 v79, v39, v87, v79 op_sel:[1,0,0] op_sel_hi:[1,0,0]
    s_waitcnt vmcnt(14)
    v_fma_mix_f32 v72, v40, v88, v72 op_sel_hi:[1,0,0]
    v_fma_mix_f32 v73, v40, v88, v73 op_sel:[1,0,0] op_sel_hi:[1,0,0]
    v_fma_mix_f32 v74, v41, v88, v74 op_sel_hi:[1,0,0]
    v_fma_mix_f32 v75, v41, v88, v75 op_sel:[1,0,0] op_sel_hi:[1,0,0]
    v_fma_mix_f32 v76, v42, v88, v76 op_sel_hi:[1,0,0]
    v_fma_mix_f32 v77, v42, v88, v77 op_sel:[1,0,0] op_sel_hi:[1,0,0]
    v_fma_mix_f32 v78, v43, v88, v78 op_sel_hi:[1,0,0]
    v_fma_mix_f32 v79, v43, v88, v79 op_sel:[1,0,0] op_sel_hi:[1,0,0]
    s_waitcnt vmcnt(12)
    v_fma_mix_f32 v72, v44, v89, v72 op_sel_hi:[1,0,0]
    v_fma_mix_f32 v73, v44, v89, v73 op_sel:[1,0,0] op_sel_hi:[1,0,0]
    v_fma_mix_f32 v74, v45, v89, v74 op_sel_hi:[1,0,0]
    v_fma_mix_f32 v75, v45, v89, v75 op_sel:[1,0,0] op_sel_hi:[1,0,0]
    v_fma_mix_f32 v76, v46, v89, v76 op_sel_hi:[1,0,0]
    v_fma_mix_f32 v77, v46, v89, v77 op_sel:[1,0,0] op_sel_hi:[1,0,0]
    v_fma_mix_f32 v78, v47, v89, v78 op_sel_hi:[1,0,0]
    v_fma_mix_f32 v79, v47, v89, v79 op_sel:[1,0,0] op_sel_hi:[1,0,0]
    s_waitcnt vmcnt(10)
    v_fma_mix_f32 v72, v48, v90, v72 op_sel_hi:[1,0,0]
    v_fma_mix_f32 v73, v48, v90, v73 op_sel:[1,0,0] op_sel_hi:[1,0,0]
    v_fma_mix_f32 v74, v49, v90, v74 op_sel_hi:[1,0,0]
    v_fma_mix_f32 v75, v49, v90, v75 op_sel:[1,0,0] op_sel_hi:[1,0,0]
    v_fma_mix_f32 v76, v50, v90, v76 op_sel_hi:[1,0,0]
    v_fma_mix_f32 v77, v50, v90, v77 op_sel:[1,0,0] op_sel_hi:[1,0,0]
    v_fma_mix_f32 v78, v51, v90, v78 op_sel_hi:[1,0,0]
    v_fma_mix_f32 v79, v51, v90, v79 op_sel:[1,0,0] op_sel_hi:[1,0,0]
    s_waitcnt vmcnt(8)
    v_fma_mix_f32 v72, v52, v91, v72 op_sel_hi:[1,0,0]
    v_fma_mix_f32 v73, v52, v91, v73 op_sel:[1,0,0] op_sel_hi:[1,0,0]
    v_fma_mix_f32 v74, v53, v91, v74 op_sel_hi:[1,0,0]
    v_fma_mix_f32 v75, v53, v91, v75 op_sel:[1,0,0] op_sel_hi:[1,0,0]
    v_fma_mix_f32 v76, v54, v91, v76 op_sel_hi:[1,0,0]
    v_fma_mix_f32 v77, v54, v91, v77 op_sel:[1,0,0] op_sel_hi:[1,0,0]
    v_fma_mix_f32 v78, v55, v91, v78 op_sel_hi:[1,0,0]
    v_fma_mix_f32 v79, v55, v91, v79 op_sel:[1,0,0] op_sel_hi:[1,0,0]
    s_waitcnt vmcnt(6)
    v_fma_mix_f32 v72, v56, v92, v72 op_sel_hi:[1,0,0]
    v_fma_mix_f32 v73, v56, v92, v73 op_sel:[1,0,0] op_sel_hi:[1,0,0]
    v_fma_mix_f32 v74, v57, v92, v74 op_sel_hi:[1,0,0]
    v_fma_mix_f32 v75, v57, v92, v75 op_sel:[1,0,0] op_sel_hi:[1,0,0]
    v_fma_mix_f32 v76, v58, v92, v76 op_sel_hi:[1,0,0]
    v_fma_mix_f32 v77, v58, v92, v77 op_sel:[1,0,0] op_sel_hi:[1,0,0]
    v_fma_mix_f32 v78, v59, v92, v78 op_sel_hi:[1,0,0]
    v_fma_mix_f32 v79, v59, v92, v79 op_sel:[1,0,0] op_sel_hi:[1,0,0]
    s_waitcnt vmcnt(4)
    v_fma_mix_f32 v72, v60, v93, v72 op_sel_hi:[1,0,0]
    v_fma_mix_f32 v73, v60, v93, v73 op_sel:[1,0,0] op_sel_hi:[1,0,0]
    v_fma_mix_f32 v74, v61, v93, v74 op_sel_hi:[1,0,0]
    v_fma_mix_f32 v75, v61, v93, v75 op_sel:[1,0,0] op_sel_hi:[1,0,0]
    v_fma_mix_f32 v76, v62, v93, v76 op_sel_hi:[1,0,0]
    v_fma_mix_f32 v77, v62, v93, v77 op_sel:[1,0,0] op_sel_hi:[1,0,0]
    v_fma_mix_f32 v78, v63, v93, v78 op_sel_hi:[1,0,0]
    v_fma_mix_f32 v79, v63, v93, v79 op_sel:[1,0,0] op_sel_hi:[1,0,0]
    s_waitcnt vmcnt(2)
    v_fma_mix_f32 v72, v64, v94, v72 op_sel_hi:[1,0,0]
    v_fma_mix_f32 v73, v64, v94, v73 op_sel:[1,0,0] op_sel_hi:[1,0,0]
    v_fma_mix_f32 v74, v65, v94, v74 op_sel_hi:[1,0,0]
    v_fma_mix_f32 v75, v65, v94, v75 op_sel:[1,0,0] op_sel_hi:[1,0,0]
    v_fma_mix_f32 v76, v66, v94, v76 op_sel_hi:[1,0,0]
    v_fma_mix_f32 v77, v66, v94, v77 op_sel:[1,0,0] op_sel_hi:[1,0,0]
    v_fma_mix_f32 v78, v67, v94, v78 op_sel_hi:[1,0,0]
    v_fma_mix_f32 v79, v67, v94, v79 op_sel:[1,0,0] op_sel_hi:[1,0,0]
    s_waitcnt vmcnt(0)
    v_fma_mix_f32 v72, v68, v95, v72 op_sel_hi:[1,0,0]
    v_fma_mix_f32 v73, v68, v95, v73 op_sel:[1,0,0] op_sel_hi:[1,0,0]
    v_fma_mix_f32 v74, v69, v95, v74 op_sel_hi:[1,0,0]
    v_fma_mix_f32 v75, v69, v95, v75 op_sel:[1,0,0] op_sel_hi:[1,0,0]
    v_fma_mix_f32 v76, v70, v95, v76 op_sel_hi:[1,0,0]
    v_fma_mix_f32 v77, v70, v95, v77 op_sel:[1,0,0] op_sel_hi:[1,0,0]
    v_fma_mix_f32 v78, v71, v95, v78 op_sel_hi:[1,0,0]
    v_fma_mix_f32 v79, v71, v95, v79 op_sel:[1,0,0] op_sel_hi:[1,0,0]
    v_cvt_pk_bf16_f32 v8, v72, v73
    v_cvt_pk_bf16_f32 v9, v74, v75
    v_cvt_pk_bf16_f32 v10, v76, v77
    v_cvt_pk_bf16_f32 v11, v78, v79
    buffer_store_dwordx2 v[8:9], v4, s[8:11], s29 offen
    s_add_u32 s29, s29, 14336
    buffer_store_dwordx2 v[10:11], v4, s[8:11], s29 offen
    s_waitcnt vmcnt(0)
L_red_end:
    s_endpgm
.section .rodata,"a"
.p2align 6
.amdhsa_kernel standalone__mha_block_cached__near_ridge_kernel
  .amdhsa_next_free_vgpr 384
  .amdhsa_next_free_sgpr 102
  .amdhsa_accum_offset 256
  .amdhsa_group_segment_fixed_size 0
  .amdhsa_kernarg_size 64
  .amdhsa_user_sgpr_count 2
  .amdhsa_user_sgpr_kernarg_segment_ptr 1
  .amdhsa_system_sgpr_workgroup_id_x 1
.end_amdhsa_kernel
.p2align 6
.amdhsa_kernel reduce_kernel
  .amdhsa_next_free_vgpr 96
  .amdhsa_next_free_sgpr 40
  .amdhsa_accum_offset 96
  .amdhsa_group_segment_fixed_size 0
  .amdhsa_kernarg_size 64
  .amdhsa_user_sgpr_count 2
  .amdhsa_user_sgpr_kernarg_segment_ptr 1
  .amdhsa_system_sgpr_workgroup_id_x 1
.end_amdhsa_kernel
```
